```python
import torch

def _softmax(x, axis=-1):
    return torch.softmax(x, dim=axis)
def _gelu(x):
    return torch.nn.functional.gelu(x, approximate="tanh")
def _silu(x):
    return torch.nn.functional.silu(x)
def _sigmoid(x):
    return torch.sigmoid(x)
def _layernorm(x, axis=-1, eps=1e-5):
    m = x.mean(dim=axis, keepdim=True)
    v = x.var(dim=axis, keepdim=True, unbiased=False)
    return (x - m) / torch.sqrt(v + eps)
def _scatter_add(tgt, idx, src, axis=0):
    return tgt.clone().index_add_(axis, idx, src)
def _segment_sum(src, seg, n):
    out = torch.zeros((n,) + src.shape[1:], dtype=src.dtype)
    return out.index_add_(0, seg, src)
def _pad(x, pw):
    flat = tuple(v for pair in reversed(pw) for v in pair)
    return torch.nn.functional.pad(x, flat)

kernel_name = 'sequential_preLN__linear_kernel_hedgehog__glu_gated_glu__prompt'

def setup_inputs():

    _w = (lambda a: (lambda t: t.to(torch.bfloat16) if t.is_floating_point() else t)(torch.as_tensor(a)))
    def _A_setup():
        B, S, D, H = 1, 2048, 448, 16
        Dh = D // H
        return {
            "x": _w((lambda *s: torch.randn(*s, dtype=torch.bfloat16) * 0.05)(B, S, D)),
            "wqkv": _w((lambda *s: torch.randn(*s, dtype=torch.bfloat16) * 0.2)(D, 3 * D)),
            "w_phi": _w((lambda *s: torch.randn(*s, dtype=torch.bfloat16) * 0.2)(H, Dh, Dh) * (Dh ** -0.5)),
            "wo": _w((lambda *s: torch.randn(*s, dtype=torch.bfloat16) * 0.05)(D, D)),
        }
    _A_in = _A_setup()

    def _B_setup():
        B, S, D, F = 1, 2048, 448, 1792
        return {
            "x": _w((lambda *s: torch.randn(*s, dtype=torch.bfloat16) * 0.05)(B, S, D)),
            "w_gate": _w((lambda *s: torch.randn(*s, dtype=torch.bfloat16) * 0.05)(D, F)),
            "w_up": _w((lambda *s: torch.randn(*s, dtype=torch.bfloat16) * 0.05)(D, F)),
            "w_down": _w((lambda *s: torch.randn(*s, dtype=torch.bfloat16) * 0.05)(F, D)),
        }
    _B_in = _B_setup()

    return {
        "A_x": _A_in["x"],
        "A_wqkv": _A_in["wqkv"],
        "A_w_phi": _A_in["w_phi"],
        "A_wo": _A_in["wo"],
        "B_x": _B_in["x"],
        "B_w_gate": _B_in["w_gate"],
        "B_w_up": _B_in["w_up"],
        "B_w_down": _B_in["w_down"],
    }

def reference(A_x, A_wqkv, A_w_phi, A_wo, B_x, B_w_gate, B_w_up, B_w_down):
    def _A_ref(x, wqkv, w_phi, wo):
        B, S, D = x.shape
        H = 16; Dh = D // H
        qkv = (lambda x, *d: x.permute(*d))((x @ wqkv).reshape(B, S, 3, H, Dh), 2, 0, 3, 1, 4)
        q, k, v = qkv[0], qkv[1], qkv[2]
        pq = torch.einsum("bhsd,hdf->bhsf", q, w_phi)
        pk = torch.einsum("bhsd,hdf->bhsf", k, w_phi)
        phi_q = torch.concatenate([_softmax(pq, axis=-1), _softmax(-pq, axis=-1)], axis=-1)
        phi_k = torch.concatenate([_softmax(pk, axis=-1), _softmax(-pk, axis=-1)], axis=-1)
        kv = torch.einsum("bhsf,bhsd->bhfd", phi_k, v)
        z  = torch.einsum("bhsf->bhf", phi_k)
        num = torch.einsum("bhqf,bhfd->bhqd", phi_q, kv)
        den = torch.einsum("bhqf,bhf->bhq", phi_q, z)[..., None] + 1e-6
        o = num / den
        return (lambda x, *d: x.permute(*d))(o, 0, 2, 1, 3).reshape(B, S, D) @ wo

    def _B_ref(x, w_gate, w_up, w_down):
        g = torch.einsum("bsd,df->bsf", x, w_gate)
        u = torch.einsum("bsd,df->bsf", x, w_up)
        h = _sigmoid(g) * u
        return torch.einsum("bsf,fd->bsd", h, w_down)

    x = A_x
    h = x + _A_ref(_layernorm(x, axis=-1), A_wqkv, A_w_phi, A_wo)
    h2 = h + _B_ref(_layernorm(h, axis=-1), B_w_gate, B_w_up, B_w_down)
    return h2
```

```asm
; @launch kernel=k1_kernel grid=(256,1,1) block=(512,1,1) lds=156736
; @launch kernel=kb_kernel grid=(256,1,1) block=(256,1,1) lds=163840
.amdgcn_target "amdgcn-amd-amdhsa--gfx950"
.text
.globl k1_kernel
.p2align 8
.type k1_kernel,@function
k1_kernel:
    s_cmp_ge_u32 s2, 256
    s_cbranch_scc1 K1_done
    s_load_dwordx2 s[8:9], s[0:1], 0
    s_mov_b32 s10, 0x1c0000
    s_mov_b32 s11, 0x00020000
    s_load_dwordx2 s[12:13], s[0:1], 8
    s_mov_b32 s14, 0x126000
    s_mov_b32 s15, 0x00020000
    s_load_dwordx2 s[16:17], s[0:1], 16
    s_mov_b32 s18, 0x6200
    s_mov_b32 s19, 0x00020000
    s_load_dwordx2 s[20:21], s[0:1], 72
    s_mov_b32 s22, 0x100
    s_mov_b32 s23, 0x00020000
    s_load_dwordx2 s[24:25], s[0:1], 80
    s_mov_b32 s26, 0x2000000
    s_mov_b32 s27, 0x00020000
    v_lshrrev_b32 v1, 6, v0
    s_nop 0
    v_readfirstlane_b32 s3, v1
    v_and_b32 v1, 63, v0
    s_and_b32 s30, s2, 7
    s_lshr_b32 s31, s2, 3
    s_lshr_b32 s4, s30, 1
    s_lshl_b32 s4, s4, 2
    s_and_b32 s32, s31, 3
    s_add_u32 s4, s4, s32
    s_and_b32 s5, s30, 1
    s_lshl_b32 s5, s5, 3
    s_lshr_b32 s32, s31, 2
    s_add_u32 s5, s5, s32
    s_and_b32 s6, s3, 3
    s_lshr_b32 s7, s3, 2
    s_cmp_ge_u32 s2, 112
    s_cselect_b32 s58, 56, 40
    s_cmp_ge_u32 s2, 224
    s_cselect_b32 s58, 24, s58
    s_load_dwordx2 s[56:57], s[0:1], s58
    s_load_dwordx2 s[60:61], s[0:1], 48
    v_lshrrev_b32 v15, 3, v1
    v_and_b32 v16, 7, v1
    v_lshrrev_b32 v17, 1, v15
    s_lshl_b32 s32, s4, 7
    s_lshl_b32 s33, s3, 4
    s_add_u32 s32, s32, s33
    v_add_u32 v18, s32, v15
    v_mul_u32_u24 v18, 896, v18
    v_xor_b32 v19, v16, v17
    v_lshl_add_u32 v2, v19, 4, v18
    v_xor_b32 v19, 4, v19
    v_lshl_add_u32 v3, v19, 4, v18
    v_add_u32 v3, 7168, v3
    v_lshrrev_b32 v15, 2, v1
    s_lshl_b32 s32, s6, 4
    v_add_u32 v15, s32, v15
    v_and_b32 v16, 3, v1
    v_lshlrev_b32 v14, 6, v15
    v_lshl_add_u32 v14, v16, 1, v14
    v_add_u32 v14, 57400, v14
    v_mul_u32_u24 v15, 2688, v15
    v_lshl_add_u32 v4, v16, 4, v15
    s_mul_i32 s32, s5, 56
    v_add_u32 v4, s32, v4
    s_lshl_b32 s37, s3, 11
    s_add_u32 s37, s37, 86016
    s_lshl_b32 s38, s6, 10
    s_waitcnt lgkmcnt(0)
    s_cmp_ge_u32 s2, 16
    s_cbranch_scc1 K1_nozero
    v_mov_b32 v20, 0
    v_mov_b32 v21, 0
    v_mov_b32 v22, 0
    v_mov_b32 v23, 0
    v_lshlrev_b32 v19, 4, v0
    s_lshl_b32 s32, s2, 13
    s_add_u32 s32, s32, 0x400000
    buffer_store_dwordx4 v[20:23], v19, s[24:27], s32 offen sc1
K1_nozero:
    s_cmp_eq_u32 s7, 0
    s_cbranch_scc0 K1_kh1
    s_mov_b32 s41, 0
    s_add_u32 m0, s38, 0
    s_nop 0
    buffer_load_dwordx4 v4, s[12:15], s41 offen lds
    s_mov_b32 s41, 896
    s_add_u32 m0, s38, 28672
    s_nop 0
    buffer_load_dwordx4 v4, s[12:15], s41 offen lds
    s_movk_i32 s40, 0
    s_add_u32 m0, s37, 0
    s_nop 0
    buffer_load_dwordx4 v2, s[8:11], s40 offen lds
    s_add_u32 m0, s37, 1024
    s_nop 0
    buffer_load_dwordx4 v3, s[8:11], s40 offen lds
    s_mov_b32 s41, 172032
    s_add_u32 m0, s38, 4096
    s_nop 0
    buffer_load_dwordx4 v4, s[12:15], s41 offen lds
    s_mov_b32 s41, 172928
    s_add_u32 m0, s38, 32768
    s_nop 0
    buffer_load_dwordx4 v4, s[12:15], s41 offen lds
    s_movk_i32 s40, 128
    s_add_u32 m0, s37, 16384
    s_nop 0
    buffer_load_dwordx4 v2, s[8:11], s40 offen lds
    s_add_u32 m0, s37, 17408
    s_nop 0
    buffer_load_dwordx4 v3, s[8:11], s40 offen lds
    v_and_b32 v15, 31, v1
    v_lshrrev_b32 v16, 5, v1
    v_lshrrev_b32 v17, 3, v15
    s_lshl_b32 s32, s6, 2
    v_add_u32 v17, s32, v17
    v_lshlrev_b32 v17, 10, v17
    v_and_b32 v18, 7, v15
    v_lshl_add_u32 v17, v18, 7, v17
    v_add_u32 v17, 86016, v17
    v_bfe_u32 v18, v15, 1, 3
    v_add_u32 v19, 0, v16
    v_xor_b32 v5, v19, v18
    v_lshl_add_u32 v5, v5, 4, v17
    v_add_u32 v19, 4, v19
    v_xor_b32 v6, v19, v18
    v_lshl_add_u32 v6, v6, 4, v17
    v_bfe_u32 v15, v1, 4, 1
    v_bfe_u32 v17, v1, 2, 2
    v_and_b32 v18, 3, v1
    v_lshl_add_u32 v7, v16, 3, v17
    v_lshlrev_b32 v7, 6, v7
    v_lshl_add_u32 v7, v15, 5, v7
    v_lshl_add_u32 v7, v18, 3, v7
    v_add_u32 v8, 57344, v7
    v_mov_b32 v10, 0x3f803f80
    v_mov_b32 v11, 0
    v_mov_b32 v12, 0
    v_bfe_u32 v15, v1, 3, 2
    v_bfe_u32 v17, v1, 2, 1
    v_lshl_add_u32 v15, v15, 2, v18
    v_mad_u32_u24 v17, v17, 14, v15
    v_lshlrev_b32 v17, 1, v17
    v_mul_u32_u24 v19, 224, v16
    v_add_u32 v17, v17, v19
    v_add_u32 v17, 154624, v17
    v_mov_b32 v28, v17
    s_mov_b32 s36, 0x3fb8aa3b
    s_cmp_ge_u32 s6, 2
    s_cbranch_scc1 K1_nophi
    s_mul_i32 s32, s5, 1568
    s_lshl_b32 s33, s6, 10
    s_add_u32 s32, s32, s33
    s_add_u32 m0, s33, 154624
    v_lshlrev_b32 v19, 4, v1
    buffer_load_dwordx4 v19, s[16:19], s32 offen lds
K1_nophi:
    s_waitcnt vmcnt(4)
    s_waitcnt lgkmcnt(0)
    s_barrier
    s_cmp_ge_u32 s2, 16
    s_cbranch_scc1 K1_noflag
    s_cmp_lg_u32 s3, 0
    s_cbranch_scc1 K1_noflag
    v_mov_b32 v20, 1
    v_mov_b32 v21, 0
    s_lshl_b32 s32, s2, 2
    s_mov_b64 exec, 1
    buffer_store_dword v20, v21, s[20:23], s32 offen sc1
    s_mov_b64 exec, -1
K1_noflag:
    ds_read_b128 v[32:35], v5 offset:0
    ds_read_b64_tr_b16 v[36:37], v7 offset:0
    ds_read_b64_tr_b16 v[38:39], v7 offset:256
    ds_read_b64_tr_b16 v[40:41], v7 offset:28672
    ds_read_b64_tr_b16 v[42:43], v7 offset:28928
    ds_read_b64_tr_b16 v[44:45], v8 offset:0
    ds_read_b64_tr_b16 v[46:47], v8 offset:256
    ds_read_b128 v[48:51], v6 offset:0
    ds_read_b64_tr_b16 v[52:53], v7 offset:2048
    ds_read_b64_tr_b16 v[54:55], v7 offset:2304
    ds_read_b64_tr_b16 v[56:57], v7 offset:30720
    ds_read_b64_tr_b16 v[58:59], v7 offset:30976
    ds_read_b64_tr_b16 v[60:61], v8 offset:2048
    ds_read_b64_tr_b16 v[62:63], v8 offset:2304
    s_mov_b32 s41, 344064
    s_add_u32 m0, s38, 8192
    s_nop 0
    buffer_load_dwordx4 v4, s[12:15], s41 offen lds
    s_mov_b32 s41, 344960
    s_add_u32 m0, s38, 36864
    s_nop 0
    buffer_load_dwordx4 v4, s[12:15], s41 offen lds
    s_movk_i32 s40, 256
    s_add_u32 m0, s37, 32768
    s_nop 0
    buffer_load_dwordx4 v2, s[8:11], s40 offen lds
    s_add_u32 m0, s37, 33792
    s_nop 0
    buffer_load_dwordx4 v3, s[8:11], s40 offen lds
    s_waitcnt vmcnt(4)
    s_waitcnt lgkmcnt(0)
    s_barrier
    v_mfma_f32_32x32x16_bf16 v[96:111], v[36:39], v[32:35], 0
    ds_read_b128 v[64:67], v5 offset:16384
    ds_read_b64_tr_b16 v[68:69], v7 offset:4096
    s_mov_b32 s41, 516096
    s_add_u32 m0, s38, 12288
    s_nop 0
    buffer_load_dwordx4 v4, s[12:15], s41 offen lds
    s_cmp_eq_u32 s6, 0
    s_cbranch_scc0 K1_cs_0_0_0
    v_dot2_f32_bf16 v11, v36, v10, v11
    v_dot2_f32_bf16 v12, v37, v10, v12
    v_dot2_f32_bf16 v11, v38, v10, v11
    v_dot2_f32_bf16 v12, v39, v10, v12
K1_cs_0_0_0:
    v_mfma_f32_32x32x16_bf16 v[112:127], v[40:43], v[32:35], 0
    ds_read_b64_tr_b16 v[70:71], v7 offset:4352
    ds_read_b64_tr_b16 v[72:73], v7 offset:32768
    s_mov_b32 s41, 516992
    s_add_u32 m0, s38, 40960
    s_nop 0
    buffer_load_dwordx4 v4, s[12:15], s41 offen lds
    s_cmp_eq_u32 s6, 1
    s_cbranch_scc0 K1_cs_0_0_1
    v_dot2_f32_bf16 v11, v40, v10, v11
    v_dot2_f32_bf16 v12, v41, v10, v12
    v_dot2_f32_bf16 v11, v42, v10, v11
    v_dot2_f32_bf16 v12, v43, v10, v12
K1_cs_0_0_1:
    v_mfma_f32_32x32x16_bf16 v[128:143], v[44:47], v[32:35], 0
    ds_read_b64_tr_b16 v[74:75], v7 offset:33024
    ds_read_b64_tr_b16 v[76:77], v8 offset:4096
    s_movk_i32 s40, 384
    s_add_u32 m0, s37, 49152
    s_nop 0
    buffer_load_dwordx4 v2, s[8:11], s40 offen lds
    s_cmp_eq_u32 s6, 2
    s_cbranch_scc0 K1_cs_0_0_2
    v_dot2_f32_bf16 v11, v44, v10, v11
    v_dot2_f32_bf16 v12, v45, v10, v12
    v_dot2_f32_bf16 v11, v46, v10, v11
    v_dot2_f32_bf16 v12, v47, v10, v12
K1_cs_0_0_2:
    v_mfma_f32_32x32x16_bf16 v[144:159], v[32:35], v[32:35], 0
    ds_read_b64_tr_b16 v[78:79], v8 offset:4352
    ds_read_b128 v[80:83], v6 offset:16384
    s_add_u32 m0, s37, 50176
    s_nop 0
    buffer_load_dwordx4 v3, s[8:11], s40 offen lds
    v_mfma_f32_32x32x16_bf16 v[96:111], v[52:55], v[48:51], v[96:111]
    ds_read_b64_tr_b16 v[84:85], v7 offset:6144
    ds_read_b64_tr_b16 v[86:87], v7 offset:6400
    s_cmp_eq_u32 s6, 0
    s_cbranch_scc0 K1_cs_0_2_0
    v_dot2_f32_bf16 v11, v52, v10, v11
    v_dot2_f32_bf16 v12, v53, v10, v12
    v_dot2_f32_bf16 v11, v54, v10, v11
    v_dot2_f32_bf16 v12, v55, v10, v12
K1_cs_0_2_0:
    v_mfma_f32_32x32x16_bf16 v[112:127], v[56:59], v[48:51], v[112:127]
    ds_read_b64_tr_b16 v[88:89], v7 offset:34816
    ds_read_b64_tr_b16 v[90:91], v7 offset:35072
    s_cmp_eq_u32 s6, 1
    s_cbranch_scc0 K1_cs_0_2_1
    v_dot2_f32_bf16 v11, v56, v10, v11
    v_dot2_f32_bf16 v12, v57, v10, v12
    v_dot2_f32_bf16 v11, v58, v10, v11
    v_dot2_f32_bf16 v12, v59, v10, v12
K1_cs_0_2_1:
    v_mfma_f32_32x32x16_bf16 v[128:143], v[60:63], v[48:51], v[128:143]
    ds_read_b64_tr_b16 v[92:93], v8 offset:6144
    ds_read_b64_tr_b16 v[94:95], v8 offset:6400
    s_cmp_eq_u32 s6, 2
    s_cbranch_scc0 K1_cs_0_2_2
    v_dot2_f32_bf16 v11, v60, v10, v11
    v_dot2_f32_bf16 v12, v61, v10, v12
    v_dot2_f32_bf16 v11, v62, v10, v11
    v_dot2_f32_bf16 v12, v63, v10, v12
K1_cs_0_2_2:
    v_mfma_f32_32x32x16_bf16 v[144:159], v[48:51], v[48:51], v[144:159]
    s_waitcnt vmcnt(4)
    s_waitcnt lgkmcnt(0)
    s_barrier
    v_mfma_f32_32x32x16_bf16 v[96:111], v[68:71], v[64:67], v[96:111]
    ds_read_b128 v[32:35], v5 offset:32768
    ds_read_b64_tr_b16 v[36:37], v7 offset:8192
    s_mov_b32 s41, 688128
    s_add_u32 m0, s38, 16384
    s_nop 0
    buffer_load_dwordx4 v4, s[12:15], s41 offen lds
    s_cmp_eq_u32 s6, 0
    s_cbranch_scc0 K1_cs_0_4_0
    v_dot2_f32_bf16 v11, v68, v10, v11
    v_dot2_f32_bf16 v12, v69, v10, v12
    v_dot2_f32_bf16 v11, v70, v10, v11
    v_dot2_f32_bf16 v12, v71, v10, v12
K1_cs_0_4_0:
    v_mfma_f32_32x32x16_bf16 v[112:127], v[72:75], v[64:67], v[112:127]
    ds_read_b64_tr_b16 v[38:39], v7 offset:8448
    ds_read_b64_tr_b16 v[40:41], v7 offset:36864
    s_mov_b32 s41, 689024
    s_add_u32 m0, s38, 45056
    s_nop 0
    buffer_load_dwordx4 v4, s[12:15], s41 offen lds
    s_cmp_eq_u32 s6, 1
    s_cbranch_scc0 K1_cs_0_4_1
    v_dot2_f32_bf16 v11, v72, v10, v11
    v_dot2_f32_bf16 v12, v73, v10, v12
    v_dot2_f32_bf16 v11, v74, v10, v11
    v_dot2_f32_bf16 v12, v75, v10, v12
K1_cs_0_4_1:
    v_mfma_f32_32x32x16_bf16 v[128:143], v[76:79], v[64:67], v[128:143]
    ds_read_b64_tr_b16 v[42:43], v7 offset:37120
    ds_read_b64_tr_b16 v[44:45], v8 offset:8192
    s_movk_i32 s40, 512
    s_add_u32 m0, s37, 0
    s_nop 0
    buffer_load_dwordx4 v2, s[8:11], s40 offen lds
    s_cmp_eq_u32 s6, 2
    s_cbranch_scc0 K1_cs_0_4_2
    v_dot2_f32_bf16 v11, v76, v10, v11
    v_dot2_f32_bf16 v12, v77, v10, v12
    v_dot2_f32_bf16 v11, v78, v10, v11
    v_dot2_f32_bf16 v12, v79, v10, v12
K1_cs_0_4_2:
    v_mfma_f32_32x32x16_bf16 v[144:159], v[64:67], v[64:67], v[144:159]
    ds_read_b64_tr_b16 v[46:47], v8 offset:8448
    ds_read_b128 v[48:51], v6 offset:32768
    s_add_u32 m0, s37, 1024
    s_nop 0
    buffer_load_dwordx4 v3, s[8:11], s40 offen lds
    v_mfma_f32_32x32x16_bf16 v[96:111], v[84:87], v[80:83], v[96:111]
    ds_read_b64_tr_b16 v[52:53], v7 offset:10240
    ds_read_b64_tr_b16 v[54:55], v7 offset:10496
    s_cmp_eq_u32 s6, 0
    s_cbranch_scc0 K1_cs_0_6_0
    v_dot2_f32_bf16 v11, v84, v10, v11
    v_dot2_f32_bf16 v12, v85, v10, v12
    v_dot2_f32_bf16 v11, v86, v10, v11
    v_dot2_f32_bf16 v12, v87, v10, v12
K1_cs_0_6_0:
    v_mfma_f32_32x32x16_bf16 v[112:127], v[88:91], v[80:83], v[112:127]
    ds_read_b64_tr_b16 v[56:57], v7 offset:38912
    ds_read_b64_tr_b16 v[58:59], v7 offset:39168
    s_cmp_eq_u32 s6, 1
    s_cbranch_scc0 K1_cs_0_6_1
    v_dot2_f32_bf16 v11, v88, v10, v11
    v_dot2_f32_bf16 v12, v89, v10, v12
    v_dot2_f32_bf16 v11, v90, v10, v11
    v_dot2_f32_bf16 v12, v91, v10, v12
K1_cs_0_6_1:
    v_mfma_f32_32x32x16_bf16 v[128:143], v[92:95], v[80:83], v[128:143]
    ds_read_b64_tr_b16 v[60:61], v8 offset:10240
    ds_read_b64_tr_b16 v[62:63], v8 offset:10496
    s_cmp_eq_u32 s6, 2
    s_cbranch_scc0 K1_cs_0_6_2
    v_dot2_f32_bf16 v11, v92, v10, v11
    v_dot2_f32_bf16 v12, v93, v10, v12
    v_dot2_f32_bf16 v11, v94, v10, v11
    v_dot2_f32_bf16 v12, v95, v10, v12
K1_cs_0_6_2:
    v_mfma_f32_32x32x16_bf16 v[144:159], v[80:83], v[80:83], v[144:159]
    s_waitcnt vmcnt(4)
    s_waitcnt lgkmcnt(0)
    s_barrier
    v_mfma_f32_32x32x16_bf16 v[96:111], v[36:39], v[32:35], v[96:111]
    ds_read_b128 v[64:67], v5 offset:49152
    ds_read_b64_tr_b16 v[68:69], v7 offset:12288
    s_mov_b32 s41, 860160
    s_add_u32 m0, s38, 20480
    s_nop 0
    buffer_load_dwordx4 v4, s[12:15], s41 offen lds
    s_cmp_eq_u32 s6, 0
    s_cbranch_scc0 K1_cs_0_8_0
    v_dot2_f32_bf16 v11, v36, v10, v11
    v_dot2_f32_bf16 v12, v37, v10, v12
    v_dot2_f32_bf16 v11, v38, v10, v11
    v_dot2_f32_bf16 v12, v39, v10, v12
K1_cs_0_8_0:
    v_mfma_f32_32x32x16_bf16 v[112:127], v[40:43], v[32:35], v[112:127]
    ds_read_b64_tr_b16 v[70:71], v7 offset:12544
    ds_read_b64_tr_b16 v[72:73], v7 offset:40960
    s_mov_b32 s41, 861056
    s_add_u32 m0, s38, 49152
    s_nop 0
    buffer_load_dwordx4 v4, s[12:15], s41 offen lds
    s_cmp_eq_u32 s6, 1
    s_cbranch_scc0 K1_cs_0_8_1
    v_dot2_f32_bf16 v11, v40, v10, v11
    v_dot2_f32_bf16 v12, v41, v10, v12
    v_dot2_f32_bf16 v11, v42, v10, v11
    v_dot2_f32_bf16 v12, v43, v10, v12
K1_cs_0_8_1:
    v_mfma_f32_32x32x16_bf16 v[128:143], v[44:47], v[32:35], v[128:143]
    ds_read_b64_tr_b16 v[74:75], v7 offset:41216
    ds_read_b64_tr_b16 v[76:77], v8 offset:12288
    s_movk_i32 s40, 640
    s_add_u32 m0, s37, 16384
    s_nop 0
    buffer_load_dwordx4 v2, s[8:11], s40 offen lds
    s_cmp_eq_u32 s6, 2
    s_cbranch_scc0 K1_cs_0_8_2
    v_dot2_f32_bf16 v11, v44, v10, v11
    v_dot2_f32_bf16 v12, v45, v10, v12
    v_dot2_f32_bf16 v11, v46, v10, v11
    v_dot2_f32_bf16 v12, v47, v10, v12
K1_cs_0_8_2:
    v_mfma_f32_32x32x16_bf16 v[144:159], v[32:35], v[32:35], v[144:159]
    ds_read_b64_tr_b16 v[78:79], v8 offset:12544
    ds_read_b128 v[80:83], v6 offset:49152
    s_add_u32 m0, s37, 17408
    s_nop 0
    buffer_load_dwordx4 v3, s[8:11], s40 offen lds
    v_mfma_f32_32x32x16_bf16 v[96:111], v[52:55], v[48:51], v[96:111]
    ds_read_b64_tr_b16 v[84:85], v7 offset:14336
    ds_read_b64_tr_b16 v[86:87], v7 offset:14592
    s_cmp_eq_u32 s6, 0
    s_cbranch_scc0 K1_cs_0_10_0
    v_dot2_f32_bf16 v11, v52, v10, v11
    v_dot2_f32_bf16 v12, v53, v10, v12
    v_dot2_f32_bf16 v11, v54, v10, v11
    v_dot2_f32_bf16 v12, v55, v10, v12
K1_cs_0_10_0:
    v_mfma_f32_32x32x16_bf16 v[112:127], v[56:59], v[48:51], v[112:127]
    ds_read_b64_tr_b16 v[88:89], v7 offset:43008
    ds_read_b64_tr_b16 v[90:91], v7 offset:43264
    s_cmp_eq_u32 s6, 1
    s_cbranch_scc0 K1_cs_0_10_1
    v_dot2_f32_bf16 v11, v56, v10, v11
    v_dot2_f32_bf16 v12, v57, v10, v12
    v_dot2_f32_bf16 v11, v58, v10, v11
    v_dot2_f32_bf16 v12, v59, v10, v12
K1_cs_0_10_1:
    v_mfma_f32_32x32x16_bf16 v[128:143], v[60:63], v[48:51], v[128:143]
    ds_read_b64_tr_b16 v[92:93], v8 offset:14336
    ds_read_b64_tr_b16 v[94:95], v8 offset:14592
    s_cmp_eq_u32 s6, 2
    s_cbranch_scc0 K1_cs_0_10_2
    v_dot2_f32_bf16 v11, v60, v10, v11
    v_dot2_f32_bf16 v12, v61, v10, v12
    v_dot2_f32_bf16 v11, v62, v10, v11
    v_dot2_f32_bf16 v12, v63, v10, v12
K1_cs_0_10_2:
    v_mfma_f32_32x32x16_bf16 v[144:159], v[48:51], v[48:51], v[144:159]
    s_waitcnt vmcnt(4)
    s_waitcnt lgkmcnt(0)
    s_barrier
    v_mfma_f32_32x32x16_bf16 v[96:111], v[68:71], v[64:67], v[96:111]
    ds_read_b128 v[32:35], v5 offset:0
    ds_read_b64_tr_b16 v[36:37], v7 offset:16384
    s_mov_b32 s41, 1032192
    s_add_u32 m0, s38, 24576
    s_nop 0
    buffer_load_dwordx4 v4, s[12:15], s41 offen lds
    s_cmp_eq_u32 s6, 0
    s_cbranch_scc0 K1_cs_0_12_0
    v_dot2_f32_bf16 v11, v68, v10, v11
    v_dot2_f32_bf16 v12, v69, v10, v12
    v_dot2_f32_bf16 v11, v70, v10, v11
    v_dot2_f32_bf16 v12, v71, v10, v12
K1_cs_0_12_0:
    v_mfma_f32_32x32x16_bf16 v[112:127], v[72:75], v[64:67], v[112:127]
    ds_read_b64_tr_b16 v[38:39], v7 offset:16640
    ds_read_b64_tr_b16 v[40:41], v7 offset:45056
    s_mov_b32 s41, 1033088
    s_add_u32 m0, s38, 53248
    s_nop 0
    buffer_load_dwordx4 v4, s[12:15], s41 offen lds
    s_cmp_eq_u32 s6, 1
    s_cbranch_scc0 K1_cs_0_12_1
    v_dot2_f32_bf16 v11, v72, v10, v11
    v_dot2_f32_bf16 v12, v73, v10, v12
    v_dot2_f32_bf16 v11, v74, v10, v11
    v_dot2_f32_bf16 v12, v75, v10, v12
K1_cs_0_12_1:
    v_mfma_f32_32x32x16_bf16 v[128:143], v[76:79], v[64:67], v[128:143]
    ds_read_b64_tr_b16 v[42:43], v7 offset:45312
    ds_read_b64_tr_b16 v[44:45], v8 offset:16384
    s_movk_i32 s40, 768
    s_add_u32 m0, s37, 32768
    s_nop 0
    buffer_load_dwordx4 v2, s[8:11], s40 offen lds
    s_cmp_eq_u32 s6, 2
    s_cbranch_scc0 K1_cs_0_12_2
    v_dot2_f32_bf16 v11, v76, v10, v11
    v_dot2_f32_bf16 v12, v77, v10, v12
    v_dot2_f32_bf16 v11, v78, v10, v11
    v_dot2_f32_bf16 v12, v79, v10, v12
K1_cs_0_12_2:
    v_mfma_f32_32x32x16_bf16 v[144:159], v[64:67], v[64:67], v[144:159]
    ds_read_b64_tr_b16 v[46:47], v8 offset:16640
    ds_read_b128 v[48:51], v6 offset:0
    s_add_u32 m0, s37, 33792
    s_nop 0
    buffer_load_dwordx4 v3, s[8:11], s40 offen lds
    v_mfma_f32_32x32x16_bf16 v[96:111], v[84:87], v[80:83], v[96:111]
    ds_read_b64_tr_b16 v[52:53], v7 offset:18432
    ds_read_b64_tr_b16 v[54:55], v7 offset:18688
    s_cmp_eq_u32 s6, 0
    s_cbranch_scc0 K1_cs_0_14_0
    v_dot2_f32_bf16 v11, v84, v10, v11
    v_dot2_f32_bf16 v12, v85, v10, v12
    v_dot2_f32_bf16 v11, v86, v10, v11
    v_dot2_f32_bf16 v12, v87, v10, v12
K1_cs_0_14_0:
    v_mfma_f32_32x32x16_bf16 v[112:127], v[88:91], v[80:83], v[112:127]
    ds_read_b64_tr_b16 v[56:57], v7 offset:47104
    ds_read_b64_tr_b16 v[58:59], v7 offset:47360
    s_cmp_eq_u32 s6, 1
    s_cbranch_scc0 K1_cs_0_14_1
    v_dot2_f32_bf16 v11, v88, v10, v11
    v_dot2_f32_bf16 v12, v89, v10, v12
    v_dot2_f32_bf16 v11, v90, v10, v11
    v_dot2_f32_bf16 v12, v91, v10, v12
K1_cs_0_14_1:
    v_mfma_f32_32x32x16_bf16 v[128:143], v[92:95], v[80:83], v[128:143]
    ds_read_b64_tr_b16 v[60:61], v8 offset:18432
    ds_read_b64_tr_b16 v[62:63], v8 offset:18688
    s_cmp_eq_u32 s6, 2
    s_cbranch_scc0 K1_cs_0_14_2
    v_dot2_f32_bf16 v11, v92, v10, v11
    v_dot2_f32_bf16 v12, v93, v10, v12
    v_dot2_f32_bf16 v11, v94, v10, v11
    v_dot2_f32_bf16 v12, v95, v10, v12
K1_cs_0_14_2:
    v_mfma_f32_32x32x16_bf16 v[144:159], v[80:83], v[80:83], v[144:159]
    s_waitcnt vmcnt(4)
    s_waitcnt lgkmcnt(0)
    s_barrier
    v_mfma_f32_32x32x16_bf16 v[96:111], v[36:39], v[32:35], v[96:111]
    ds_read_b128 v[64:67], v5 offset:16384
    ds_read_b64_tr_b16 v[68:69], v7 offset:20480
    s_cmp_eq_u32 s6, 0
    s_cbranch_scc0 K1_cs_0_16_0
    v_dot2_f32_bf16 v11, v36, v10, v11
    v_dot2_f32_bf16 v12, v37, v10, v12
    v_dot2_f32_bf16 v11, v38, v10, v11
    v_dot2_f32_bf16 v12, v39, v10, v12
K1_cs_0_16_0:
    v_mfma_f32_32x32x16_bf16 v[112:127], v[40:43], v[32:35], v[112:127]
    ds_read_b64_tr_b16 v[70:71], v7 offset:20736
    ds_read_b64_tr_b16 v[72:73], v7 offset:49152
    s_cmp_eq_u32 s6, 1
    s_cbranch_scc0 K1_cs_0_16_1
    v_dot2_f32_bf16 v11, v40, v10, v11
    v_dot2_f32_bf16 v12, v41, v10, v12
    v_dot2_f32_bf16 v11, v42, v10, v11
    v_dot2_f32_bf16 v12, v43, v10, v12
K1_cs_0_16_1:
    v_mfma_f32_32x32x16_bf16 v[128:143], v[44:47], v[32:35], v[128:143]
    ds_read_b64_tr_b16 v[74:75], v7 offset:49408
    ds_read_b64_tr_b16 v[76:77], v8 offset:20480
    s_cmp_eq_u32 s6, 2
    s_cbranch_scc0 K1_cs_0_16_2
    v_dot2_f32_bf16 v11, v44, v10, v11
    v_dot2_f32_bf16 v12, v45, v10, v12
    v_dot2_f32_bf16 v11, v46, v10, v11
    v_dot2_f32_bf16 v12, v47, v10, v12
K1_cs_0_16_2:
    v_mfma_f32_32x32x16_bf16 v[144:159], v[32:35], v[32:35], v[144:159]
    ds_read_b64_tr_b16 v[78:79], v8 offset:20736
    ds_read_b128 v[80:83], v6 offset:16384
    v_mfma_f32_32x32x16_bf16 v[96:111], v[52:55], v[48:51], v[96:111]
    ds_read_b64_tr_b16 v[84:85], v7 offset:22528
    ds_read_b64_tr_b16 v[86:87], v7 offset:22784
    s_cmp_eq_u32 s6, 0
    s_cbranch_scc0 K1_cs_0_18_0
    v_dot2_f32_bf16 v11, v52, v10, v11
    v_dot2_f32_bf16 v12, v53, v10, v12
    v_dot2_f32_bf16 v11, v54, v10, v11
    v_dot2_f32_bf16 v12, v55, v10, v12
K1_cs_0_18_0:
    v_mfma_f32_32x32x16_bf16 v[112:127], v[56:59], v[48:51], v[112:127]
    ds_read_b64_tr_b16 v[88:89], v7 offset:51200
    ds_read_b64_tr_b16 v[90:91], v7 offset:51456
    s_cmp_eq_u32 s6, 1
    s_cbranch_scc0 K1_cs_0_18_1
    v_dot2_f32_bf16 v11, v56, v10, v11
    v_dot2_f32_bf16 v12, v57, v10, v12
    v_dot2_f32_bf16 v11, v58, v10, v11
    v_dot2_f32_bf16 v12, v59, v10, v12
K1_cs_0_18_1:
    v_mfma_f32_32x32x16_bf16 v[128:143], v[60:63], v[48:51], v[128:143]
    ds_read_b64_tr_b16 v[92:93], v8 offset:22528
    ds_read_b64_tr_b16 v[94:95], v8 offset:22784
    s_cmp_eq_u32 s6, 2
    s_cbranch_scc0 K1_cs_0_18_2
    v_dot2_f32_bf16 v11, v60, v10, v11
    v_dot2_f32_bf16 v12, v61, v10, v12
    v_dot2_f32_bf16 v11, v62, v10, v11
    v_dot2_f32_bf16 v12, v63, v10, v12
K1_cs_0_18_2:
    v_mfma_f32_32x32x16_bf16 v[144:159], v[48:51], v[48:51], v[144:159]
    s_mov_b32 s59, 0x00020000
    s_mov_b32 s63, 0x00020000
    s_mov_b32 s58, 0x188000
    s_mov_b32 s62, 0x188000
    s_cmp_ge_u32 s2, 224
    s_cbranch_scc1 SL0_wo
    s_cmp_ge_u32 s2, 112
    s_cbranch_scc1 SL0_dn
    v_lshrrev_b32 v216, 3, v1
    v_and_b32 v217, 7, v1
    v_lshlrev_b32 v217, 4, v217
    s_lshr_b32 s40, s2, 2
    s_lshl_b32 s40, s40, 7
    v_add_u32 v217, s40, v217
    s_and_b32 s41, s2, 3
    s_mul_i32 s41, s41, 56
    s_and_b32 s42, s3, 3
    s_cmp_ge_u32 s3, 4
    s_cselect_b32 s56, s60, s56
    s_cselect_b32 s57, s61, s57
    s_mov_b32 s43, 135168
    s_cselect_b32 s43, 57344, s43
    s_movk_i32 s46, 4682
    s_movk_i32 s47, 3584
    s_add_u32 s44, s42, 0
    s_lshr_b32 s45, s44, 1
    s_lshl_b32 s45, s45, 3
    s_add_u32 s45, s45, s41
    v_add_u32 v218, s45, v216
    v_mul_u32_u24 v219, s46, v218
    v_lshrrev_b32 v219, 16, v219
    v_mad_u32_u24 v218, v219, 14, v218
    v_mad_u32_u24 v218, v218, s47, v217
    s_and_b32 s45, s44, 1
    s_mul_i32 s45, s45, 50176
    s_lshl_b32 s44, s44, 10
    s_add_u32 m0, s43, s44
    s_nop 0
    buffer_load_dwordx4 v218, s[56:59], s45 offen lds
    s_add_u32 s44, s42, 4
    s_lshr_b32 s45, s44, 1
    s_lshl_b32 s45, s45, 3
    s_add_u32 s45, s45, s41
    v_add_u32 v218, s45, v216
    v_mul_u32_u24 v219, s46, v218
    v_lshrrev_b32 v219, 16, v219
    v_mad_u32_u24 v218, v219, 14, v218
    v_mad_u32_u24 v218, v218, s47, v217
    s_and_b32 s45, s44, 1
    s_mul_i32 s45, s45, 50176
    s_lshl_b32 s44, s44, 10
    s_add_u32 m0, s43, s44
    s_nop 0
    buffer_load_dwordx4 v218, s[56:59], s45 offen lds
    s_add_u32 s44, s42, 8
    s_lshr_b32 s45, s44, 1
    s_lshl_b32 s45, s45, 3
    s_add_u32 s45, s45, s41
    v_add_u32 v218, s45, v216
    v_mul_u32_u24 v219, s46, v218
    v_lshrrev_b32 v219, 16, v219
    v_mad_u32_u24 v218, v219, 14, v218
    v_mad_u32_u24 v218, v218, s47, v217
    s_and_b32 s45, s44, 1
    s_mul_i32 s45, s45, 50176
    s_lshl_b32 s44, s44, 10
    s_add_u32 m0, s43, s44
    s_nop 0
    buffer_load_dwordx4 v218, s[56:59], s45 offen lds
    s_add_u32 s44, s42, 12
    s_cmp_ge_u32 s42, 2
    s_cselect_b32 s44, s42, s44
    s_lshr_b32 s45, s44, 1
    s_lshl_b32 s45, s45, 3
    s_add_u32 s45, s45, s41
    v_add_u32 v218, s45, v216
    v_mul_u32_u24 v219, s46, v218
    v_lshrrev_b32 v219, 16, v219
    v_mad_u32_u24 v218, v219, 14, v218
    v_mad_u32_u24 v218, v218, s47, v217
    s_and_b32 s45, s44, 1
    s_mul_i32 s45, s45, 50176
    s_lshl_b32 s44, s44, 10
    s_add_u32 m0, s43, s44
    s_nop 0
    buffer_load_dwordx4 v218, s[56:59], s45 offen lds
    s_branch SL0_end
SL0_dn:
    v_lshlrev_b32 v216, 4, v1
    s_sub_u32 s40, s2, 112
    s_mul_i32 s40, s40, 14336
    s_lshl_b32 s41, s3, 10
    s_add_u32 s40, s40, s41
    s_add_u32 m0, s41, 135168
    s_nop 0
    buffer_load_dwordx4 v216, s[56:59], s40 offen lds
    s_cmp_ge_u32 s3, 6
    s_cselect_b32 s42, 0, 8192
    s_add_u32 s40, s40, s42
    s_add_u32 s41, s41, s42
    s_add_u32 m0, s41, 135168
    s_nop 0
    buffer_load_dwordx4 v216, s[56:59], s40 offen lds
    buffer_load_dwordx4 v216, s[56:59], s40 offen lds
    buffer_load_dwordx4 v216, s[56:59], s40 offen lds
    s_branch SL0_end
SL0_wo:
    s_mov_b32 s58, 0x62000
    v_lshrrev_b32 v216, 5, v1
    v_bfe_u32 v217, v1, 1, 4
    v_and_b32 v218, 1, v1
    v_mul_u32_u24 v216, 896, v216
    v_mad_u32_u24 v216, v217, 28, v216
    v_lshl_add_u32 v216, v218, 4, v216
    s_sub_u32 s40, s2, 224
    s_lshr_b32 s41, s40, 1
    s_mul_i32 s41, s41, 25088
    s_and_b32 s40, s40, 1
    s_mul_i32 s40, s40, 448
    s_add_u32 s40, s40, s41
    s_mul_i32 s41, s3, 1792
    s_add_u32 s40, s40, s41
    s_lshl_b32 s41, s3, 10
    s_add_u32 m0, s41, 135168
    s_nop 0
    buffer_load_dwordx4 v216, s[56:59], s40 offen lds
    s_cmp_ge_u32 s3, 6
    s_cselect_b32 s42, 0, 14336
    s_cselect_b32 s43, 0, 8192
    s_add_u32 s40, s40, s42
    s_add_u32 s41, s41, s43
    s_add_u32 m0, s41, 135168
    s_nop 0
    buffer_load_dwordx4 v216, s[56:59], s40 offen lds
    buffer_load_dwordx4 v216, s[56:59], s40 offen lds
    buffer_load_dwordx4 v216, s[56:59], s40 offen lds
SL0_end:
    s_nop 4
    s_waitcnt vmcnt(4)
    s_waitcnt lgkmcnt(0)
    s_barrier
    v_mfma_f32_32x32x16_bf16 v[96:111], v[68:71], v[64:67], v[96:111]
    ds_read_b128 v[32:35], v5 offset:32768
    ds_read_b64_tr_b16 v[36:37], v7 offset:24576
    s_cmp_eq_u32 s6, 0
    s_cbranch_scc0 K1_cs_0_20_0
    v_dot2_f32_bf16 v11, v68, v10, v11
    v_dot2_f32_bf16 v12, v69, v10, v12
    v_dot2_f32_bf16 v11, v70, v10, v11
    v_dot2_f32_bf16 v12, v71, v10, v12
K1_cs_0_20_0:
    v_mfma_f32_32x32x16_bf16 v[112:127], v[72:75], v[64:67], v[112:127]
    ds_read_b64_tr_b16 v[38:39], v7 offset:24832
    ds_read_b64_tr_b16 v[40:41], v7 offset:53248
    s_cmp_eq_u32 s6, 1
    s_cbranch_scc0 K1_cs_0_20_1
    v_dot2_f32_bf16 v11, v72, v10, v11
    v_dot2_f32_bf16 v12, v73, v10, v12
    v_dot2_f32_bf16 v11, v74, v10, v11
    v_dot2_f32_bf16 v12, v75, v10, v12
K1_cs_0_20_1:
    v_mfma_f32_32x32x16_bf16 v[128:143], v[76:79], v[64:67], v[128:143]
    ds_read_b64_tr_b16 v[42:43], v7 offset:53504
    ds_read_b64_tr_b16 v[44:45], v8 offset:24576
    s_cmp_eq_u32 s6, 2
    s_cbranch_scc0 K1_cs_0_20_2
    v_dot2_f32_bf16 v11, v76, v10, v11
    v_dot2_f32_bf16 v12, v77, v10, v12
    v_dot2_f32_bf16 v11, v78, v10, v11
    v_dot2_f32_bf16 v12, v79, v10, v12
K1_cs_0_20_2:
    v_mfma_f32_32x32x16_bf16 v[144:159], v[64:67], v[64:67], v[144:159]
    ds_read_b64_tr_b16 v[46:47], v8 offset:24832
    ds_read_b128 v[48:51], v6 offset:32768
    v_mfma_f32_32x32x16_bf16 v[96:111], v[84:87], v[80:83], v[96:111]
    ds_read_b64_tr_b16 v[52:53], v7 offset:26624
    ds_read_b64_tr_b16 v[54:55], v7 offset:26880
    s_cmp_eq_u32 s6, 0
    s_cbranch_scc0 K1_cs_0_22_0
    v_dot2_f32_bf16 v11, v84, v10, v11
    v_dot2_f32_bf16 v12, v85, v10, v12
    v_dot2_f32_bf16 v11, v86, v10, v11
    v_dot2_f32_bf16 v12, v87, v10, v12
K1_cs_0_22_0:
    v_mfma_f32_32x32x16_bf16 v[112:127], v[88:91], v[80:83], v[112:127]
    ds_read_b64_tr_b16 v[56:57], v7 offset:55296
    ds_read_b64_tr_b16 v[58:59], v7 offset:55552
    s_cmp_eq_u32 s6, 1
    s_cbranch_scc0 K1_cs_0_22_1
    v_dot2_f32_bf16 v11, v88, v10, v11
    v_dot2_f32_bf16 v12, v89, v10, v12
    v_dot2_f32_bf16 v11, v90, v10, v11
    v_dot2_f32_bf16 v12, v91, v10, v12
K1_cs_0_22_1:
    v_mfma_f32_32x32x16_bf16 v[128:143], v[92:95], v[80:83], v[128:143]
    ds_read_b64_tr_b16 v[60:61], v8 offset:26624
    ds_read_b64_tr_b16 v[62:63], v8 offset:26880
    s_cmp_eq_u32 s6, 2
    s_cbranch_scc0 K1_cs_0_22_2
    v_dot2_f32_bf16 v11, v92, v10, v11
    v_dot2_f32_bf16 v12, v93, v10, v12
    v_dot2_f32_bf16 v11, v94, v10, v11
    v_dot2_f32_bf16 v12, v95, v10, v12
K1_cs_0_22_2:
    v_mfma_f32_32x32x16_bf16 v[144:159], v[80:83], v[80:83], v[144:159]
    s_waitcnt lgkmcnt(0)
    v_mfma_f32_32x32x16_bf16 v[96:111], v[36:39], v[32:35], v[96:111]
    s_cmp_eq_u32 s6, 0
    s_cbranch_scc0 K1_cs_0_24_0
    v_dot2_f32_bf16 v11, v36, v10, v11
    v_dot2_f32_bf16 v12, v37, v10, v12
    v_dot2_f32_bf16 v11, v38, v10, v11
    v_dot2_f32_bf16 v12, v39, v10, v12
K1_cs_0_24_0:
    v_mfma_f32_32x32x16_bf16 v[112:127], v[40:43], v[32:35], v[112:127]
    s_cmp_eq_u32 s6, 1
    s_cbranch_scc0 K1_cs_0_24_1
    v_dot2_f32_bf16 v11, v40, v10, v11
    v_dot2_f32_bf16 v12, v41, v10, v12
    v_dot2_f32_bf16 v11, v42, v10, v11
    v_dot2_f32_bf16 v12, v43, v10, v12
K1_cs_0_24_1:
    v_mfma_f32_32x32x16_bf16 v[128:143], v[44:47], v[32:35], v[128:143]
    s_cmp_eq_u32 s6, 2
    s_cbranch_scc0 K1_cs_0_24_2
    v_dot2_f32_bf16 v11, v44, v10, v11
    v_dot2_f32_bf16 v12, v45, v10, v12
    v_dot2_f32_bf16 v11, v46, v10, v11
    v_dot2_f32_bf16 v12, v47, v10, v12
K1_cs_0_24_2:
    v_mfma_f32_32x32x16_bf16 v[144:159], v[32:35], v[32:35], v[144:159]
    v_mfma_f32_32x32x16_bf16 v[96:111], v[52:55], v[48:51], v[96:111]
    s_cmp_eq_u32 s6, 0
    s_cbranch_scc0 K1_cs_0_26_0
    v_dot2_f32_bf16 v11, v52, v10, v11
    v_dot2_f32_bf16 v12, v53, v10, v12
    v_dot2_f32_bf16 v11, v54, v10, v11
    v_dot2_f32_bf16 v12, v55, v10, v12
K1_cs_0_26_0:
    v_mfma_f32_32x32x16_bf16 v[112:127], v[56:59], v[48:51], v[112:127]
    s_cmp_eq_u32 s6, 1
    s_cbranch_scc0 K1_cs_0_26_1
    v_dot2_f32_bf16 v11, v56, v10, v11
    v_dot2_f32_bf16 v12, v57, v10, v12
    v_dot2_f32_bf16 v11, v58, v10, v11
    v_dot2_f32_bf16 v12, v59, v10, v12
K1_cs_0_26_1:
    v_mfma_f32_32x32x16_bf16 v[128:143], v[60:63], v[48:51], v[128:143]
    s_cmp_eq_u32 s6, 2
    s_cbranch_scc0 K1_cs_0_26_2
    v_dot2_f32_bf16 v11, v60, v10, v11
    v_dot2_f32_bf16 v12, v61, v10, v12
    v_dot2_f32_bf16 v11, v62, v10, v11
    v_dot2_f32_bf16 v12, v63, v10, v12
K1_cs_0_26_2:
    v_mfma_f32_32x32x16_bf16 v[144:159], v[48:51], v[48:51], v[144:159]
    s_mul_i32 s32, s6, 6144
    v_lshlrev_b32 v19, 4, v1
    v_add_u32 v18, s32, v19
    ds_write_b128 v18, v[112:115] offset:0
    ds_write_b128 v18, v[116:119] offset:1024
    ds_write_b128 v18, v[120:123] offset:2048
    ds_write_b128 v18, v[124:127] offset:3072
    s_nop 1
    ds_write_b128 v18, v[136:139] offset:4096
    ds_write_b128 v18, v[140:143] offset:5120
    v_add_f32 v11, v11, v12
    v_mov_b32 v12, v11
    s_nop 1
    v_permlane32_swap_b32 v11, v12
    v_add_f32 v11, v11, v12
    v_and_b32 v17, 31, v1
    s_lshl_b32 s32, s6, 8
    s_add_u32 s32, s32, 153600
    v_lshl_add_u32 v17, v17, 2, s32
    ds_write_b32 v17, v11
    v_and_b32 v15, 31, v1
    v_and_b32 v16, 3, v1
    v_bfe_u32 v17, v1, 3, 2
    v_cmp_eq_u32 s[42:43], 1, v16
    v_cmp_eq_u32 s[44:45], 2, v16
    v_cmp_eq_u32 s[46:47], 3, v16
    v_cmp_eq_u32 s[50:51], 1, v17
    v_cmp_eq_u32 s[52:53], 2, v17
    v_cmp_eq_u32 s[54:55], 3, v17
    v_cndmask_b32 v144, v144, v145, s[42:43]
    v_cndmask_b32 v144, v144, v146, s[44:45]
    v_cndmask_b32 v144, v144, v147, s[46:47]
    v_cndmask_b32 v148, v148, v149, s[42:43]
    v_cndmask_b32 v148, v148, v150, s[44:45]
    v_cndmask_b32 v148, v148, v151, s[46:47]
    v_cndmask_b32 v152, v152, v153, s[42:43]
    v_cndmask_b32 v152, v152, v154, s[44:45]
    v_cndmask_b32 v152, v152, v155, s[46:47]
    v_cndmask_b32 v156, v156, v157, s[42:43]
    v_cndmask_b32 v156, v156, v158, s[44:45]
    v_cndmask_b32 v156, v156, v159, s[46:47]
    v_cndmask_b32 v144, v144, v148, s[50:51]
    v_cndmask_b32 v144, v144, v152, s[52:53]
    v_cndmask_b32 v144, v144, v156, s[54:55]
    s_lshl_b32 s32, s6, 5
    v_add_u32 v16, s32, v15
    v_lshlrev_b32 v17, 3, v16
    v_add_u32 v17, 151552, v17
    s_mov_b32 exec_lo, 0
    ds_write_b32 v17, v140 offset:0
    s_mov_b32 exec_lo, 0x0f0f0f0f
    s_mov_b32 exec_hi, 0xf0f0f0f0
    ds_write_b32 v17, v144 offset:4
    s_mov_b64 exec, -1
    s_waitcnt vmcnt(0) lgkmcnt(0)
    s_barrier
    ds_read_b128 v[32:35], v18 offset:28672
    ds_read_b128 v[36:39], v18 offset:29696
    ds_read_b128 v[40:43], v18 offset:30720
    ds_read_b128 v[44:47], v18 offset:31744
    ds_read_b128 v[48:51], v18 offset:32768
    ds_read_b128 v[52:55], v18 offset:33792
    ds_read_b64 v[10:11], v17
    ds_read_b64 v[12:13], v17 offset:1024
    v_lshrrev_b32 v18, 5, v1
    v_lshlrev_b32 v18, 4, v18
    v_add_u32 v18, 153600, v18
    ds_read_b128 v[144:147], v18 offset:0
    ds_read_b128 v[148:151], v18 offset:32
    ds_read_b128 v[152:155], v18 offset:64
    ds_read_b128 v[156:159], v18 offset:96
    ds_read_b128 v[160:163], v18 offset:512
    ds_read_b128 v[164:167], v18 offset:544
    ds_read_b128 v[168:171], v18 offset:128
    ds_read_b128 v[172:175], v18 offset:160
    ds_read_b128 v[176:179], v18 offset:192
    ds_read_b128 v[180:183], v18 offset:224
    ds_read_b128 v[184:187], v18 offset:640
    ds_read_b128 v[188:191], v18 offset:672
    s_waitcnt lgkmcnt(12)
    v_add_f32 v10, v10, v12
    v_add_f32 v11, v11, v13
    v_mul_f32 v10, 0xbb124925, v10
    v_mul_f32 v11, 0x3b124925, v11
    v_fma_f32 v11, -v10, v10, v11
    v_max_f32 v11, 0, v11
    v_add_f32 v11, 0x3727c5ac, v11
    v_rsq_f32 v11, v11
    v_add_f32 v96, v96, v32
    v_add_f32 v97, v97, v33
    v_add_f32 v98, v98, v34
    v_add_f32 v99, v99, v35
    v_add_f32 v100, v100, v36
    v_add_f32 v101, v101, v37
    v_add_f32 v102, v102, v38
    v_add_f32 v103, v103, v39
    v_add_f32 v104, v104, v40
    v_add_f32 v105, v105, v41
    v_add_f32 v106, v106, v42
    v_add_f32 v107, v107, v43
    v_add_f32 v108, v108, v44
    v_add_f32 v109, v109, v45
    v_add_f32 v110, v110, v46
    v_add_f32 v111, v111, v47
    v_add_f32 v128, v128, v48
    v_add_f32 v129, v129, v49
    v_add_f32 v130, v130, v50
    v_add_f32 v131, v131, v51
    v_add_f32 v132, v132, v52
    v_add_f32 v133, v133, v53
    v_add_f32 v134, v134, v54
    v_add_f32 v135, v135, v55
    s_waitcnt lgkmcnt(0)
    ds_read_u16 v20, v28 offset:0
    ds_read_u16 v208, v28 offset:56
    ds_read_u16 v21, v28 offset:112
    ds_read_u16 v209, v28 offset:168
    ds_read_u16 v22, v28 offset:448
    ds_read_u16 v210, v28 offset:504
    ds_read_u16 v23, v28 offset:560
    ds_read_u16 v211, v28 offset:616
    ds_read_u16 v24, v28 offset:896
    ds_read_u16 v212, v28 offset:952
    ds_read_u16 v25, v28 offset:1008
    ds_read_u16 v213, v28 offset:1064
    ds_read_u16 v26, v28 offset:1344
    ds_read_u16 v214, v28 offset:1400
    ds_read_u16 v27, v28 offset:1456
    ds_read_u16 v215, v28 offset:1512
    v_add_f32 v144, v144, v168
    v_add_f32 v145, v145, v169
    v_add_f32 v146, v146, v170
    v_add_f32 v147, v147, v171
    v_add_f32 v148, v148, v172
    v_add_f32 v149, v149, v173
    v_add_f32 v150, v150, v174
    v_add_f32 v151, v151, v175
    v_add_f32 v152, v152, v176
    v_add_f32 v153, v153, v177
    v_add_f32 v154, v154, v178
    v_add_f32 v155, v155, v179
    v_add_f32 v156, v156, v180
    v_add_f32 v157, v157, v181
    v_add_f32 v158, v158, v182
    v_add_f32 v159, v159, v183
    v_add_f32 v160, v160, v184
    v_add_f32 v161, v161, v185
    v_add_f32 v162, v162, v186
    v_add_f32 v163, v163, v187
    v_add_f32 v164, v164, v188
    v_add_f32 v165, v165, v189
    v_add_f32 v166, v166, v190
    v_add_f32 v167, v167, v191
    v_fmac_f32 v96, v10, v144
    v_fmac_f32 v97, v10, v145
    v_fmac_f32 v98, v10, v146
    v_fmac_f32 v99, v10, v147
    v_fmac_f32 v100, v10, v148
    v_fmac_f32 v101, v10, v149
    v_fmac_f32 v102, v10, v150
    v_fmac_f32 v103, v10, v151
    v_fmac_f32 v104, v10, v152
    v_fmac_f32 v105, v10, v153
    v_fmac_f32 v106, v10, v154
    v_fmac_f32 v107, v10, v155
    v_fmac_f32 v108, v10, v156
    v_fmac_f32 v109, v10, v157
    v_fmac_f32 v110, v10, v158
    v_fmac_f32 v111, v10, v159
    v_fmac_f32 v128, v10, v160
    v_fmac_f32 v129, v10, v161
    v_fmac_f32 v130, v10, v162
    v_fmac_f32 v131, v10, v163
    v_fmac_f32 v132, v10, v164
    v_fmac_f32 v133, v10, v165
    v_fmac_f32 v134, v10, v166
    v_fmac_f32 v135, v10, v167
    v_mul_f32 v128, v128, v11
    v_mul_f32 v129, v129, v11
    v_mul_f32 v130, v130, v11
    v_mul_f32 v131, v131, v11
    v_mul_f32 v132, v132, v11
    v_mul_f32 v133, v133, v11
    v_mul_f32 v134, v134, v11
    v_mul_f32 v135, v135, v11
    v_mul_f32 v13, s36, v11
    v_cvt_pk_bf16_f32 v32, v96, v97
    v_cvt_pk_bf16_f32 v33, v98, v99
    v_cvt_pk_bf16_f32 v34, v100, v101
    v_cvt_pk_bf16_f32 v35, v102, v103
    v_cvt_pk_bf16_f32 v36, v104, v105
    v_cvt_pk_bf16_f32 v37, v106, v107
    v_cvt_pk_bf16_f32 v38, v108, v109
    v_cvt_pk_bf16_f32 v39, v110, v111
    s_mov_b32 s44, 0x33ffffff
    s_mov_b32 s45, 0x33ffffff
    s_mov_b32 s46, 0x33ffffff
    s_mov_b32 s47, 0
    s_waitcnt lgkmcnt(0)
    v_lshl_or_b32 v20, v208, 16, v20
    v_lshl_or_b32 v21, v209, 16, v21
    v_lshl_or_b32 v22, v210, 16, v22
    v_lshl_or_b32 v23, v211, 16, v23
    v_lshl_or_b32 v24, v212, 16, v24
    v_lshl_or_b32 v25, v213, 16, v25
    v_lshl_or_b32 v26, v214, 16, v26
    v_lshl_or_b32 v27, v215, 16, v27
    v_cndmask_b32 v20, 0, v20, s[44:45]
    v_cndmask_b32 v21, 0, v21, s[44:45]
    v_cndmask_b32 v22, 0, v22, s[44:45]
    v_cndmask_b32 v23, 0, v23, s[44:45]
    v_cndmask_b32 v24, 0, v24, s[44:45]
    v_cndmask_b32 v25, 0, v25, s[44:45]
    v_cndmask_b32 v26, 0, v26, s[46:47]
    v_cndmask_b32 v27, 0, v27, s[46:47]
    v_mfma_f32_32x32x16_bf16 v[144:159], v[20:23], v[32:35], 0
    s_nop 0
    v_mfma_f32_32x32x16_bf16 v[144:159], v[24:27], v[36:39], v[144:159]
    v_mul_u32_u24 v19, 192, v16
    v_lshrrev_b32 v18, 5, v1
    v_add_u32 v19, 86016, v19
    v_lshl_add_u32 v17, v18, 3, v19
    v_lshl_add_u32 v19, v18, 5, v19
    v_cvt_pk_bf16_f32 v40, v128, v129
    v_cvt_pk_bf16_f32 v41, v130, v131
    v_cvt_pk_bf16_f32 v42, v132, v133
    v_cvt_pk_bf16_f32 v43, v134, v135
    ds_write_b64 v17, v[40:41] offset:128
    ds_write_b64 v17, v[42:43] offset:144
    v_lshlrev_b32 v2, 4, v1
    s_cmp_ge_u32 s2, 48
    s_cbranch_scc1 SF_nz
    s_cmp_lg_u32 s6, 0
    s_cbranch_scc1 SF_nz
    v_mov_b32 v8, 0
    v_mov_b32 v9, 0
    v_mov_b32 v10, 0
    v_mov_b32 v11, 0
    s_lshl_b32 s32, s2, 10
    s_add_u32 s32, s32, 0xce0000
    buffer_store_dwordx4 v[8:11], v2, s[24:27], s32 offen sc1
SF_nz:
    v_bfe_u32 v3, v1, 4, 1
    v_lshrrev_b32 v4, 5, v1
    v_bfe_u32 v5, v1, 2, 2
    v_and_b32 v6, 3, v1
    s_cmp_ge_u32 s2, 224
    s_cbranch_scc1 SF_wo
    s_cmp_ge_u32 s2, 112
    s_cbranch_scc1 SF_dn
    v_lshl_add_u32 v7, v4, 3, v5
    v_lshlrev_b32 v7, 7, v7
    v_lshl_add_u32 v7, v6, 3, v7
    v_mul_u32_u24 v8, 77824, v3
    v_sub_u32 v7, v7, v8
    s_lshl_b32 s32, s6, 5
    s_add_u32 s32, s32, 135168
    v_add_u32 v7, s32, v7
    ds_read_b64_tr_b16 v[32:33], v7 offset:0
    ds_read_b64_tr_b16 v[34:35], v7 offset:512
    ds_read_b64_tr_b16 v[36:37], v7 offset:2048
    ds_read_b64_tr_b16 v[38:39], v7 offset:2560
    ds_read_b64_tr_b16 v[40:41], v7 offset:4096
    ds_read_b64_tr_b16 v[42:43], v7 offset:4608
    ds_read_b64_tr_b16 v[44:45], v7 offset:6144
    ds_read_b64_tr_b16 v[46:47], v7 offset:6656
    ds_read_b64_tr_b16 v[48:49], v7 offset:8192
    ds_read_b64_tr_b16 v[50:51], v7 offset:8704
    ds_read_b64_tr_b16 v[52:53], v7 offset:10240
    ds_read_b64_tr_b16 v[54:55], v7 offset:10752
    ds_read_b64_tr_b16 v[56:57], v7 offset:12288
    ds_read_b64_tr_b16 v[58:59], v7 offset:12800
    s_lshr_b32 s33, s2, 2
    s_lshl_b32 s33, s33, 2
    s_add_u32 s33, s33, s6
    s_mul_i32 s36, s33, 147
    s_lshr_b32 s36, s36, 10
    s_mul_i32 s39, s36, 7
    s_sub_u32 s39, s33, s39
    s_mul_i32 s36, s36, 196
    s_mov_b32 s40, s39
    s_mov_b32 s41, 3
    s_cmp_ge_u32 s39, 3
    s_cselect_b32 s41, 2, s41
    s_cselect_b32 s42, 81, 0
    s_add_u32 s40, s40, s42
    s_cmp_ge_u32 s39, 5
    s_cselect_b32 s41, 1, s41
    s_cselect_b32 s40, 140, s40
    s_cmp_ge_u32 s39, 6
    s_cselect_b32 s40, 168, s40
    s_add_u32 s36, s36, s40
    s_and_b32 s42, s2, 3
    s_mul_i32 s43, s42, 7
    s_mul_i32 s43, s43, s41
    s_add_u32 s36, s36, s43
    s_lshl_b32 s36, s36, 10
    s_add_u32 s36, s36, 0x800000
    s_lshl_b32 s41, s41, 10
    v_mov_b32 v80, 0x3f803f80
    v_mov_b32 v81, 0x3f803f80
    v_mov_b32 v82, 0x3f803f80
    v_mov_b32 v83, 0x3f803f80
    s_waitcnt lgkmcnt(12)
    buffer_store_dwordx4 v[32:35], v2, s[24:27], s36 offen sc1
    s_add_u32 s36, s36, s41
    v_mfma_f32_32x32x16_bf16 v[64:79], v[32:35], v[80:83], 0
    s_waitcnt lgkmcnt(10)
    buffer_store_dwordx4 v[36:39], v2, s[24:27], s36 offen sc1
    s_add_u32 s36, s36, s41
    v_mfma_f32_32x32x16_bf16 v[64:79], v[36:39], v[80:83], v[64:79]
    s_waitcnt lgkmcnt(8)
    buffer_store_dwordx4 v[40:43], v2, s[24:27], s36 offen sc1
    s_add_u32 s36, s36, s41
    v_mfma_f32_32x32x16_bf16 v[64:79], v[40:43], v[80:83], v[64:79]
    s_waitcnt lgkmcnt(6)
    buffer_store_dwordx4 v[44:47], v2, s[24:27], s36 offen sc1
    s_add_u32 s36, s36, s41
    v_mfma_f32_32x32x16_bf16 v[64:79], v[44:47], v[80:83], v[64:79]
    s_waitcnt lgkmcnt(4)
    buffer_store_dwordx4 v[48:51], v2, s[24:27], s36 offen sc1
    s_add_u32 s36, s36, s41
    v_mfma_f32_32x32x16_bf16 v[64:79], v[48:51], v[80:83], v[64:79]
    s_waitcnt lgkmcnt(2)
    buffer_store_dwordx4 v[52:55], v2, s[24:27], s36 offen sc1
    s_add_u32 s36, s36, s41
    v_mfma_f32_32x32x16_bf16 v[64:79], v[52:55], v[80:83], v[64:79]
    s_waitcnt lgkmcnt(0)
    buffer_store_dwordx4 v[56:59], v2, s[24:27], s36 offen sc1
    s_add_u32 s36, s36, s41
    v_mfma_f32_32x32x16_bf16 v[64:79], v[56:59], v[80:83], v[64:79]
    s_mul_i32 s42, s42, 112
    s_add_u32 s42, s42, s33
    s_lshl_b32 s42, s42, 7
    s_add_u32 s42, s42, 0xc00000
    v_lshlrev_b32 v8, 4, v4
    s_mov_b32 exec_lo, 1
    s_mov_b32 exec_hi, 1
    s_nop 4
    buffer_store_dwordx4 v[64:67], v8, s[24:27], s42 offen offset:0 sc1
    buffer_store_dwordx4 v[68:71], v8, s[24:27], s42 offen offset:32 sc1
    buffer_store_dwordx4 v[72:75], v8, s[24:27], s42 offen offset:64 sc1
    buffer_store_dwordx4 v[76:79], v8, s[24:27], s42 offen offset:96 sc1
    s_mov_b64 exec, -1
    s_branch K1_sdone
SF_dn:
    v_lshl_add_u32 v7, v4, 2, v5
    v_mul_u32_u24 v7, 896, v7
    v_lshrrev_b32 v8, 1, v6
    v_lshl_add_u32 v8, v3, 1, v8
    v_and_b32 v9, 1, v6
    v_lshl_add_u32 v8, v9, 2, v8
    v_lshl_add_u32 v7, v8, 3, v7
    s_lshl_b32 s32, s6, 6
    s_add_u32 s32, s32, 135168
    v_add_u32 v7, s32, v7
    ds_read_b64_tr_b16 v[32:33], v7 offset:0
    ds_read_b64_tr_b16 v[34:35], v7 offset:7168
    ds_read_b64_tr_b16 v[36:37], v7 offset:256
    ds_read_b64_tr_b16 v[38:39], v7 offset:7424
    ds_read_b64_tr_b16 v[40:41], v7 offset:512
    ds_read_b64_tr_b16 v[42:43], v7 offset:7680
    ds_read_b64_tr_b16 v[44:45], v7 offset:768
    ds_read_b64_tr_b16 v[46:47], v7 offset:7936
    s_mul_i32 s36, s6, 112
    s_add_u32 s36, s36, s2
    s_sub_u32 s36, s36, 112
    s_lshl_b32 s36, s36, 10
    s_add_u32 s36, s36, 0xd00000
    s_waitcnt lgkmcnt(6)
    buffer_store_dwordx4 v[32:35], v2, s[24:27], s36 offen sc1
    s_add_u32 s36, s36, 458752
    s_waitcnt lgkmcnt(4)
    buffer_store_dwordx4 v[36:39], v2, s[24:27], s36 offen sc1
    s_add_u32 s36, s36, 458752
    s_waitcnt lgkmcnt(2)
    buffer_store_dwordx4 v[40:43], v2, s[24:27], s36 offen sc1
    s_add_u32 s36, s36, 458752
    s_cmp_ge_u32 s6, 2
    s_cbranch_scc1 K1_sdone
    s_waitcnt lgkmcnt(0)
    buffer_store_dwordx4 v[44:47], v2, s[24:27], s36 offen sc1
    s_add_u32 s36, s36, 458752
    s_branch K1_sdone
SF_wo:
    v_lshrrev_b32 v8, 1, v6
    v_lshl_add_u32 v8, v3, 1, v8
    v_and_b32 v9, 1, v6
    v_lshlrev_b32 v8, 3, v8
    v_lshl_add_u32 v8, v9, 5, v8
    s_lshl_b32 s32, s6, 7
    s_add_u32 s32, s32, 135168
    v_add_u32 v8, s32, v8
    v_lshl_add_u32 v7, v4, 2, v5
    v_lshl_add_u32 v7, v7, 9, v8
    v_min_u32 v10, 1, v5
    v_lshl_add_u32 v10, v4, 1, v10
    v_add_u32 v10, 24, v10
    v_lshl_add_u32 v10, v10, 9, v8
    ds_read_b64_tr_b16 v[32:33], v7 offset:0
    ds_read_b64_tr_b16 v[34:35], v7 offset:4096
    ds_read_b64_tr_b16 v[36:37], v7 offset:8192
    ds_read_b64_tr_b16 v[38:39], v10 offset:0
    ds_read_b64_tr_b16 v[40:41], v7 offset:64
    ds_read_b64_tr_b16 v[42:43], v7 offset:4160
    ds_read_b64_tr_b16 v[44:45], v7 offset:8256
    ds_read_b64_tr_b16 v[46:47], v10 offset:64
    s_sub_u32 s33, s2, 224
    s_and_b32 s34, s33, 1
    s_lshl_b32 s34, s34, 3
    s_lshl_b32 s35, s6, 1
    s_add_u32 s34, s34, s35
    s_lshl_b32 s34, s34, 5
    s_and_b32 s33, s33, 0xfe
    s_add_u32 s34, s34, s33
    s_lshl_b32 s34, s34, 10
    s_add_u32 s34, s34, 0x700000
    s_waitcnt lgkmcnt(0)
    buffer_store_dwordx4 v[32:35], v2, s[24:27], s34 offen sc1
    buffer_store_dwordx4 v[36:39], v2, s[24:27], s34 offen offset:1024 sc1
    s_add_u32 s34, s34, 32768
    buffer_store_dwordx4 v[40:43], v2, s[24:27], s34 offen sc1
    buffer_store_dwordx4 v[44:47], v2, s[24:27], s34 offen offset:1024 sc1
    s_add_u32 s34, s34, 32768
    s_branch K1_sdone
K1_sdone:
    s_nop 7
    s_waitcnt lgkmcnt(0)
    s_barrier
    v_max3_f32 v168, v144, v145, v146
    v_min3_f32 v169, v144, v145, v146
    v_max3_f32 v168, v168, v147, v148
    v_min3_f32 v169, v169, v147, v148
    v_max3_f32 v168, v168, v149, v150
    v_min3_f32 v169, v169, v149, v150
    v_max3_f32 v168, v168, v151, v152
    v_min3_f32 v169, v169, v151, v152
    v_max3_f32 v168, v168, v153, v154
    v_min3_f32 v169, v169, v153, v154
    v_max3_f32 v168, v168, v155, v156
    v_min3_f32 v169, v169, v155, v156
    v_max_f32 v168, v168, v157
    v_min_f32 v169, v169, v157
    v_mov_b32 v170, v168
    v_mov_b32 v171, v169
    s_nop 0
    v_permlane32_swap_b32 v168, v170
    v_permlane32_swap_b32 v169, v171
    v_max_f32 v168, v168, v170
    v_min_f32 v169, v169, v171
    v_mul_f32 v168, v13, v168
    v_mul_f32 v169, v13, v169
    v_fma_f32 v174, v144, v13, -v168
    v_fma_f32 v188, -v144, v13, v169
    v_fma_f32 v175, v145, v13, -v168
    v_fma_f32 v189, -v145, v13, v169
    v_fma_f32 v176, v146, v13, -v168
    v_fma_f32 v190, -v146, v13, v169
    v_fma_f32 v177, v147, v13, -v168
    v_fma_f32 v191, -v147, v13, v169
    v_fma_f32 v178, v148, v13, -v168
    v_fma_f32 v192, -v148, v13, v169
    v_fma_f32 v179, v149, v13, -v168
    v_fma_f32 v193, -v149, v13, v169
    v_fma_f32 v180, v150, v13, -v168
    v_fma_f32 v194, -v150, v13, v169
    v_fma_f32 v181, v151, v13, -v168
    v_fma_f32 v195, -v151, v13, v169
    v_fma_f32 v182, v152, v13, -v168
    v_fma_f32 v196, -v152, v13, v169
    v_fma_f32 v183, v153, v13, -v168
    v_fma_f32 v197, -v153, v13, v169
    v_fma_f32 v184, v154, v13, -v168
    v_fma_f32 v198, -v154, v13, v169
    v_fma_f32 v185, v155, v13, -v168
    v_fma_f32 v199, -v155, v13, v169
    v_fma_f32 v186, v156, v13, -v168
    v_fma_f32 v200, -v156, v13, v169
    v_fma_f32 v187, v157, v13, -v168
    v_fma_f32 v201, -v157, v13, v169
    v_exp_f32 v174, v174
    v_exp_f32 v188, v188
    v_exp_f32 v175, v175
    v_exp_f32 v189, v189
    v_exp_f32 v176, v176
    v_exp_f32 v190, v190
    v_exp_f32 v177, v177
    v_exp_f32 v191, v191
    v_exp_f32 v178, v178
    v_exp_f32 v192, v192
    v_exp_f32 v179, v179
    v_exp_f32 v193, v193
    v_exp_f32 v180, v180
    v_exp_f32 v194, v194
    v_exp_f32 v181, v181
    v_exp_f32 v195, v195
    v_exp_f32 v182, v182
    v_exp_f32 v196, v196
    v_exp_f32 v183, v183
    v_exp_f32 v197, v197
    v_exp_f32 v184, v184
    v_exp_f32 v198, v198
    v_exp_f32 v185, v185
    v_exp_f32 v199, v199
    v_exp_f32 v186, v186
    v_exp_f32 v200, v200
    v_exp_f32 v187, v187
    v_exp_f32 v201, v201
    v_add_f32 v172, v174, v175
    v_add_f32 v173, v188, v189
    v_add_f32 v172, v172, v176
    v_add_f32 v173, v173, v190
    v_add_f32 v172, v172, v177
    v_add_f32 v173, v173, v191
    v_add_f32 v172, v172, v178
    v_add_f32 v173, v173, v192
    v_add_f32 v172, v172, v179
    v_add_f32 v173, v173, v193
    v_add_f32 v172, v172, v180
    v_add_f32 v173, v173, v194
    v_add_f32 v172, v172, v181
    v_add_f32 v173, v173, v195
    v_add_f32 v172, v172, v182
    v_add_f32 v173, v173, v196
    v_add_f32 v172, v172, v183
    v_add_f32 v173, v173, v197
    v_add_f32 v172, v172, v184
    v_add_f32 v173, v173, v198
    v_add_f32 v172, v172, v185
    v_add_f32 v173, v173, v199
    v_add_f32 v172, v172, v186
    v_add_f32 v173, v173, v200
    v_add_f32 v172, v172, v187
    v_add_f32 v173, v173, v201
    v_mov_b32 v170, v172
    v_mov_b32 v171, v173
    s_nop 0
    v_permlane32_swap_b32 v172, v170
    v_permlane32_swap_b32 v173, v171
    v_add_f32 v172, v172, v170
    v_add_f32 v173, v173, v171
    v_rcp_f32 v172, v172
    v_rcp_f32 v173, v173
    v_mul_f32 v174, v174, v172
    v_mul_f32 v188, v188, v173
    v_mul_f32 v175, v175, v172
    v_mul_f32 v189, v189, v173
    v_mul_f32 v176, v176, v172
    v_mul_f32 v190, v190, v173
    v_mul_f32 v177, v177, v172
    v_mul_f32 v191, v191, v173
    v_mul_f32 v178, v178, v172
    v_mul_f32 v192, v192, v173
    v_mul_f32 v179, v179, v172
    v_mul_f32 v193, v193, v173
    v_mul_f32 v180, v180, v172
    v_mul_f32 v194, v194, v173
    v_mul_f32 v181, v181, v172
    v_mul_f32 v195, v195, v173
    v_mul_f32 v182, v182, v172
    v_mul_f32 v196, v196, v173
    v_mul_f32 v183, v183, v172
    v_mul_f32 v197, v197, v173
    v_mul_f32 v184, v184, v172
    v_mul_f32 v198, v198, v173
    v_mul_f32 v185, v185, v172
    v_mul_f32 v199, v199, v173
    v_mul_f32 v186, v186, v172
    v_mul_f32 v200, v200, v173
    v_mul_f32 v187, v187, v172
    v_mul_f32 v201, v201, v173
    v_cvt_pk_bf16_f32 v48, v174, v175
    v_cvt_pk_bf16_f32 v56, v188, v189
    v_cvt_pk_bf16_f32 v49, v176, v177
    v_cvt_pk_bf16_f32 v57, v190, v191
    v_cvt_pk_bf16_f32 v50, v178, v179
    v_cvt_pk_bf16_f32 v58, v192, v193
    v_cvt_pk_bf16_f32 v51, v180, v181
    v_cvt_pk_bf16_f32 v59, v194, v195
    v_cvt_pk_bf16_f32 v52, v182, v183
    v_cvt_pk_bf16_f32 v60, v196, v197
    v_cvt_pk_bf16_f32 v53, v184, v185
    v_cvt_pk_bf16_f32 v61, v198, v199
    v_cvt_pk_bf16_f32 v54, v186, v187
    v_cvt_pk_bf16_f32 v62, v200, v201
    v_mov_b32 v55, 0
    v_mov_b32 v63, 0
    s_lshl_b32 s32, s4, 2
    s_add_u32 s32, s32, s6
    s_lshl_b32 s32, s32, 4
    s_add_u32 s32, s32, s5
    s_lshl_b32 s32, s32, 12
    v_lshlrev_b32 v18, 4, v1
    buffer_store_dwordx4 v[48:51], v18, s[24:27], s32 offen offset:0 sc1
    buffer_store_dwordx4 v[52:55], v18, s[24:27], s32 offen offset:1024 sc1
    buffer_store_dwordx4 v[56:59], v18, s[24:27], s32 offen offset:2048 sc1
    buffer_store_dwordx4 v[60:63], v18, s[24:27], s32 offen offset:3072 sc1
    s_branch K1_fin
K1_kh1:
    s_mov_b32 s41, 1792
    s_add_u32 m0, s38, 57344
    s_nop 0
    buffer_load_dwordx4 v4, s[12:15], s41 offen lds
    s_movk_i32 s40, 0
    s_add_u32 m0, s37, 0
    s_nop 0
    buffer_load_dwordx4 v2, s[8:11], s40 offen lds
    s_add_u32 m0, s37, 1024
    s_nop 0
    buffer_load_dwordx4 v3, s[8:11], s40 offen lds
    s_mov_b32 s41, 173824
    s_add_u32 m0, s38, 61440
    s_nop 0
    buffer_load_dwordx4 v4, s[12:15], s41 offen lds
    s_movk_i32 s40, 128
    s_add_u32 m0, s37, 16384
    s_nop 0
    buffer_load_dwordx4 v2, s[8:11], s40 offen lds
    s_add_u32 m0, s37, 17408
    s_nop 0
    buffer_load_dwordx4 v3, s[8:11], s40 offen lds
    v_and_b32 v15, 31, v1
    v_lshrrev_b32 v16, 5, v1
    v_lshrrev_b32 v17, 3, v15
    s_lshl_b32 s32, s6, 2
    v_add_u32 v17, s32, v17
    v_lshlrev_b32 v17, 10, v17
    v_and_b32 v18, 7, v15
    v_lshl_add_u32 v17, v18, 7, v17
    v_add_u32 v17, 86016, v17
    v_bfe_u32 v18, v15, 1, 3
    v_add_u32 v19, 2, v16
    v_xor_b32 v5, v19, v18
    v_lshl_add_u32 v5, v5, 4, v17
    v_add_u32 v19, 4, v19
    v_xor_b32 v6, v19, v18
    v_lshl_add_u32 v6, v6, 4, v17
    v_bfe_u32 v15, v1, 4, 1
    v_bfe_u32 v17, v1, 2, 2
    v_and_b32 v18, 3, v1
    v_lshl_add_u32 v7, v16, 3, v17
    v_lshlrev_b32 v7, 6, v7
    v_lshl_add_u32 v7, v15, 5, v7
    v_lshl_add_u32 v7, v18, 3, v7
    v_add_u32 v8, 57344, v7
    v_mov_b32 v10, 0x3f803f80
    v_mov_b32 v11, 0
    v_mov_b32 v12, 0
    v_bfe_u32 v15, v1, 3, 2
    v_bfe_u32 v17, v1, 2, 1
    v_lshl_add_u32 v15, v15, 2, v18
    v_mad_u32_u24 v17, v17, 14, v15
    v_lshlrev_b32 v17, 1, v17
    v_mul_u32_u24 v19, 224, v16
    v_add_u32 v17, v17, v19
    v_add_u32 v17, 154624, v17
    v_mov_b32 v28, v17
    s_mov_b32 s36, 0x3fb8aa3b
    s_waitcnt vmcnt(3)
    ds_write_b16 v14, v10 offset:0
    s_waitcnt lgkmcnt(0)
    s_barrier
    ds_read_b128 v[32:35], v5 offset:0
    ds_read_b64_tr_b16 v[36:37], v7 offset:1024
    ds_read_b64_tr_b16 v[38:39], v7 offset:1280
    ds_read_b64_tr_b16 v[40:41], v7 offset:29696
    ds_read_b64_tr_b16 v[42:43], v7 offset:29952
    ds_read_b64_tr_b16 v[44:45], v8 offset:1024
    ds_read_b64_tr_b16 v[46:47], v8 offset:1280
    ds_read_b128 v[48:51], v6 offset:0
    ds_read_b64_tr_b16 v[52:53], v7 offset:3072
    ds_read_b64_tr_b16 v[54:55], v7 offset:3328
    ds_read_b64_tr_b16 v[56:57], v7 offset:31744
    ds_read_b64_tr_b16 v[58:59], v7 offset:32000
    ds_read_b64_tr_b16 v[60:61], v8 offset:3072
    ds_read_b64_tr_b16 v[62:63], v8 offset:3328
    s_mov_b32 s41, 345856
    s_add_u32 m0, s38, 65536
    s_nop 0
    buffer_load_dwordx4 v4, s[12:15], s41 offen lds
    s_movk_i32 s40, 256
    s_add_u32 m0, s37, 32768
    s_nop 0
    buffer_load_dwordx4 v2, s[8:11], s40 offen lds
    s_add_u32 m0, s37, 33792
    s_nop 0
    buffer_load_dwordx4 v3, s[8:11], s40 offen lds
    s_waitcnt vmcnt(3)
    ds_write_b16 v14, v10 offset:4096
    s_waitcnt lgkmcnt(0)
    s_barrier
    v_mfma_f32_32x32x16_bf16 v[96:111], v[36:39], v[32:35], 0
    ds_read_b128 v[64:67], v5 offset:16384
    ds_read_b64_tr_b16 v[68:69], v7 offset:5120
    s_mov_b32 s41, 517888
    s_add_u32 m0, s38, 69632
    s_nop 0
    buffer_load_dwordx4 v4, s[12:15], s41 offen lds
    s_cmp_eq_u32 s6, 0
    s_cbranch_scc0 K1_cs_1_1_0
    v_dot2_f32_bf16 v11, v36, v10, v11
    v_dot2_f32_bf16 v12, v37, v10, v12
    v_dot2_f32_bf16 v11, v38, v10, v11
    v_dot2_f32_bf16 v12, v39, v10, v12
K1_cs_1_1_0:
    v_mfma_f32_32x32x16_bf16 v[112:127], v[40:43], v[32:35], 0
    ds_read_b64_tr_b16 v[70:71], v7 offset:5376
    ds_read_b64_tr_b16 v[72:73], v7 offset:33792
    s_movk_i32 s40, 384
    s_add_u32 m0, s37, 49152
    s_nop 0
    buffer_load_dwordx4 v2, s[8:11], s40 offen lds
    s_cmp_eq_u32 s6, 1
    s_cbranch_scc0 K1_cs_1_1_1
    v_dot2_f32_bf16 v11, v40, v10, v11
    v_dot2_f32_bf16 v12, v41, v10, v12
    v_dot2_f32_bf16 v11, v42, v10, v11
    v_dot2_f32_bf16 v12, v43, v10, v12
K1_cs_1_1_1:
    v_mfma_f32_32x32x16_bf16 v[128:143], v[44:47], v[32:35], 0
    ds_read_b64_tr_b16 v[74:75], v7 offset:34048
    ds_read_b64_tr_b16 v[76:77], v8 offset:5120
    s_add_u32 m0, s37, 50176
    s_nop 0
    buffer_load_dwordx4 v3, s[8:11], s40 offen lds
    s_cmp_eq_u32 s6, 2
    s_cbranch_scc0 K1_cs_1_1_2
    v_dot2_f32_bf16 v11, v44, v10, v11
    v_dot2_f32_bf16 v12, v45, v10, v12
    v_dot2_f32_bf16 v11, v46, v10, v11
    v_dot2_f32_bf16 v12, v47, v10, v12
K1_cs_1_1_2:
    v_mfma_f32_32x32x16_bf16 v[144:159], v[32:35], v[32:35], 0
    ds_read_b64_tr_b16 v[78:79], v8 offset:5376
    ds_read_b128 v[80:83], v6 offset:16384
    v_mfma_f32_32x32x16_bf16 v[96:111], v[52:55], v[48:51], v[96:111]
    ds_read_b64_tr_b16 v[84:85], v7 offset:7168
    ds_read_b64_tr_b16 v[86:87], v7 offset:7424
    s_cmp_eq_u32 s6, 0
    s_cbranch_scc0 K1_cs_1_3_0
    v_dot2_f32_bf16 v11, v52, v10, v11
    v_dot2_f32_bf16 v12, v53, v10, v12
    v_dot2_f32_bf16 v11, v54, v10, v11
    v_dot2_f32_bf16 v12, v55, v10, v12
K1_cs_1_3_0:
    v_mfma_f32_32x32x16_bf16 v[112:127], v[56:59], v[48:51], v[112:127]
    ds_read_b64_tr_b16 v[88:89], v7 offset:35840
    ds_read_b64_tr_b16 v[90:91], v7 offset:36096
    s_cmp_eq_u32 s6, 1
    s_cbranch_scc0 K1_cs_1_3_1
    v_dot2_f32_bf16 v11, v56, v10, v11
    v_dot2_f32_bf16 v12, v57, v10, v12
    v_dot2_f32_bf16 v11, v58, v10, v11
    v_dot2_f32_bf16 v12, v59, v10, v12
K1_cs_1_3_1:
    v_mfma_f32_32x32x16_bf16 v[128:143], v[60:63], v[48:51], v[128:143]
    ds_read_b64_tr_b16 v[92:93], v8 offset:7168
    ds_read_b64_tr_b16 v[94:95], v8 offset:7424
    s_cmp_eq_u32 s6, 2
    s_cbranch_scc0 K1_cs_1_3_2
    v_dot2_f32_bf16 v11, v60, v10, v11
    v_dot2_f32_bf16 v12, v61, v10, v12
    v_dot2_f32_bf16 v11, v62, v10, v11
    v_dot2_f32_bf16 v12, v63, v10, v12
K1_cs_1_3_2:
    v_mfma_f32_32x32x16_bf16 v[144:159], v[48:51], v[48:51], v[144:159]
    s_waitcnt vmcnt(3)
    ds_write_b16 v14, v10 offset:8192
    s_waitcnt lgkmcnt(0)
    s_barrier
    v_mfma_f32_32x32x16_bf16 v[96:111], v[68:71], v[64:67], v[96:111]
    ds_read_b128 v[32:35], v5 offset:32768
    ds_read_b64_tr_b16 v[36:37], v7 offset:9216
    s_mov_b32 s41, 689920
    s_add_u32 m0, s38, 73728
    s_nop 0
    buffer_load_dwordx4 v4, s[12:15], s41 offen lds
    s_cmp_eq_u32 s6, 0
    s_cbranch_scc0 K1_cs_1_5_0
    v_dot2_f32_bf16 v11, v68, v10, v11
    v_dot2_f32_bf16 v12, v69, v10, v12
    v_dot2_f32_bf16 v11, v70, v10, v11
    v_dot2_f32_bf16 v12, v71, v10, v12
K1_cs_1_5_0:
    v_mfma_f32_32x32x16_bf16 v[112:127], v[72:75], v[64:67], v[112:127]
    ds_read_b64_tr_b16 v[38:39], v7 offset:9472
    ds_read_b64_tr_b16 v[40:41], v7 offset:37888
    s_movk_i32 s40, 512
    s_add_u32 m0, s37, 0
    s_nop 0
    buffer_load_dwordx4 v2, s[8:11], s40 offen lds
    s_cmp_eq_u32 s6, 1
    s_cbranch_scc0 K1_cs_1_5_1
    v_dot2_f32_bf16 v11, v72, v10, v11
    v_dot2_f32_bf16 v12, v73, v10, v12
    v_dot2_f32_bf16 v11, v74, v10, v11
    v_dot2_f32_bf16 v12, v75, v10, v12
K1_cs_1_5_1:
    v_mfma_f32_32x32x16_bf16 v[128:143], v[76:79], v[64:67], v[128:143]
    ds_read_b64_tr_b16 v[42:43], v7 offset:38144
    ds_read_b64_tr_b16 v[44:45], v8 offset:9216
    s_add_u32 m0, s37, 1024
    s_nop 0
    buffer_load_dwordx4 v3, s[8:11], s40 offen lds
    s_cmp_eq_u32 s6, 2
    s_cbranch_scc0 K1_cs_1_5_2
    v_dot2_f32_bf16 v11, v76, v10, v11
    v_dot2_f32_bf16 v12, v77, v10, v12
    v_dot2_f32_bf16 v11, v78, v10, v11
    v_dot2_f32_bf16 v12, v79, v10, v12
K1_cs_1_5_2:
    v_mfma_f32_32x32x16_bf16 v[144:159], v[64:67], v[64:67], v[144:159]
    ds_read_b64_tr_b16 v[46:47], v8 offset:9472
    ds_read_b128 v[48:51], v6 offset:32768
    v_mfma_f32_32x32x16_bf16 v[96:111], v[84:87], v[80:83], v[96:111]
    ds_read_b64_tr_b16 v[52:53], v7 offset:11264
    ds_read_b64_tr_b16 v[54:55], v7 offset:11520
    s_cmp_eq_u32 s6, 0
    s_cbranch_scc0 K1_cs_1_7_0
    v_dot2_f32_bf16 v11, v84, v10, v11
    v_dot2_f32_bf16 v12, v85, v10, v12
    v_dot2_f32_bf16 v11, v86, v10, v11
    v_dot2_f32_bf16 v12, v87, v10, v12
K1_cs_1_7_0:
    v_mfma_f32_32x32x16_bf16 v[112:127], v[88:91], v[80:83], v[112:127]
    ds_read_b64_tr_b16 v[56:57], v7 offset:39936
    ds_read_b64_tr_b16 v[58:59], v7 offset:40192
    s_cmp_eq_u32 s6, 1
    s_cbranch_scc0 K1_cs_1_7_1
    v_dot2_f32_bf16 v11, v88, v10, v11
    v_dot2_f32_bf16 v12, v89, v10, v12
    v_dot2_f32_bf16 v11, v90, v10, v11
    v_dot2_f32_bf16 v12, v91, v10, v12
K1_cs_1_7_1:
    v_mfma_f32_32x32x16_bf16 v[128:143], v[92:95], v[80:83], v[128:143]
    ds_read_b64_tr_b16 v[60:61], v8 offset:11264
    ds_read_b64_tr_b16 v[62:63], v8 offset:11520
    s_cmp_eq_u32 s6, 2
    s_cbranch_scc0 K1_cs_1_7_2
    v_dot2_f32_bf16 v11, v92, v10, v11
    v_dot2_f32_bf16 v12, v93, v10, v12
    v_dot2_f32_bf16 v11, v94, v10, v11
    v_dot2_f32_bf16 v12, v95, v10, v12
K1_cs_1_7_2:
    v_mfma_f32_32x32x16_bf16 v[144:159], v[80:83], v[80:83], v[144:159]
    s_waitcnt vmcnt(3)
    ds_write_b16 v14, v10 offset:12288
    s_waitcnt lgkmcnt(0)
    s_barrier
    v_mfma_f32_32x32x16_bf16 v[96:111], v[36:39], v[32:35], v[96:111]
    ds_read_b128 v[64:67], v5 offset:49152
    ds_read_b64_tr_b16 v[68:69], v7 offset:13312
    s_mov_b32 s41, 861952
    s_add_u32 m0, s38, 77824
    s_nop 0
    buffer_load_dwordx4 v4, s[12:15], s41 offen lds
    s_cmp_eq_u32 s6, 0
    s_cbranch_scc0 K1_cs_1_9_0
    v_dot2_f32_bf16 v11, v36, v10, v11
    v_dot2_f32_bf16 v12, v37, v10, v12
    v_dot2_f32_bf16 v11, v38, v10, v11
    v_dot2_f32_bf16 v12, v39, v10, v12
K1_cs_1_9_0:
    v_mfma_f32_32x32x16_bf16 v[112:127], v[40:43], v[32:35], v[112:127]
    ds_read_b64_tr_b16 v[70:71], v7 offset:13568
    ds_read_b64_tr_b16 v[72:73], v7 offset:41984
    s_movk_i32 s40, 640
    s_add_u32 m0, s37, 16384
    s_nop 0
    buffer_load_dwordx4 v2, s[8:11], s40 offen lds
    s_cmp_eq_u32 s6, 1
    s_cbranch_scc0 K1_cs_1_9_1
    v_dot2_f32_bf16 v11, v40, v10, v11
    v_dot2_f32_bf16 v12, v41, v10, v12
    v_dot2_f32_bf16 v11, v42, v10, v11
    v_dot2_f32_bf16 v12, v43, v10, v12
K1_cs_1_9_1:
    v_mfma_f32_32x32x16_bf16 v[128:143], v[44:47], v[32:35], v[128:143]
    ds_read_b64_tr_b16 v[74:75], v7 offset:42240
    ds_read_b64_tr_b16 v[76:77], v8 offset:13312
    s_add_u32 m0, s37, 17408
    s_nop 0
    buffer_load_dwordx4 v3, s[8:11], s40 offen lds
    s_cmp_eq_u32 s6, 2
    s_cbranch_scc0 K1_cs_1_9_2
    v_dot2_f32_bf16 v11, v44, v10, v11
    v_dot2_f32_bf16 v12, v45, v10, v12
    v_dot2_f32_bf16 v11, v46, v10, v11
    v_dot2_f32_bf16 v12, v47, v10, v12
K1_cs_1_9_2:
    v_mfma_f32_32x32x16_bf16 v[144:159], v[32:35], v[32:35], v[144:159]
    ds_read_b64_tr_b16 v[78:79], v8 offset:13568
    ds_read_b128 v[80:83], v6 offset:49152
    v_mfma_f32_32x32x16_bf16 v[96:111], v[52:55], v[48:51], v[96:111]
    ds_read_b64_tr_b16 v[84:85], v7 offset:15360
    ds_read_b64_tr_b16 v[86:87], v7 offset:15616
    s_cmp_eq_u32 s6, 0
    s_cbranch_scc0 K1_cs_1_11_0
    v_dot2_f32_bf16 v11, v52, v10, v11
    v_dot2_f32_bf16 v12, v53, v10, v12
    v_dot2_f32_bf16 v11, v54, v10, v11
    v_dot2_f32_bf16 v12, v55, v10, v12
K1_cs_1_11_0:
    v_mfma_f32_32x32x16_bf16 v[112:127], v[56:59], v[48:51], v[112:127]
    ds_read_b64_tr_b16 v[88:89], v7 offset:44032
    ds_read_b64_tr_b16 v[90:91], v7 offset:44288
    s_cmp_eq_u32 s6, 1
    s_cbranch_scc0 K1_cs_1_11_1
    v_dot2_f32_bf16 v11, v56, v10, v11
    v_dot2_f32_bf16 v12, v57, v10, v12
    v_dot2_f32_bf16 v11, v58, v10, v11
    v_dot2_f32_bf16 v12, v59, v10, v12
K1_cs_1_11_1:
    v_mfma_f32_32x32x16_bf16 v[128:143], v[60:63], v[48:51], v[128:143]
    ds_read_b64_tr_b16 v[92:93], v8 offset:15360
    ds_read_b64_tr_b16 v[94:95], v8 offset:15616
    s_cmp_eq_u32 s6, 2
    s_cbranch_scc0 K1_cs_1_11_2
    v_dot2_f32_bf16 v11, v60, v10, v11
    v_dot2_f32_bf16 v12, v61, v10, v12
    v_dot2_f32_bf16 v11, v62, v10, v11
    v_dot2_f32_bf16 v12, v63, v10, v12
K1_cs_1_11_2:
    v_mfma_f32_32x32x16_bf16 v[144:159], v[48:51], v[48:51], v[144:159]
    s_waitcnt vmcnt(3)
    ds_write_b16 v14, v10 offset:16384
    s_waitcnt lgkmcnt(0)
    s_barrier
    v_mfma_f32_32x32x16_bf16 v[96:111], v[68:71], v[64:67], v[96:111]
    ds_read_b128 v[32:35], v5 offset:0
    ds_read_b64_tr_b16 v[36:37], v7 offset:17408
    s_mov_b32 s41, 1033984
    s_add_u32 m0, s38, 81920
    s_nop 0
    buffer_load_dwordx4 v4, s[12:15], s41 offen lds
    s_cmp_eq_u32 s6, 0
    s_cbranch_scc0 K1_cs_1_13_0
    v_dot2_f32_bf16 v11, v68, v10, v11
    v_dot2_f32_bf16 v12, v69, v10, v12
    v_dot2_f32_bf16 v11, v70, v10, v11
    v_dot2_f32_bf16 v12, v71, v10, v12
K1_cs_1_13_0:
    v_mfma_f32_32x32x16_bf16 v[112:127], v[72:75], v[64:67], v[112:127]
    ds_read_b64_tr_b16 v[38:39], v7 offset:17664
    ds_read_b64_tr_b16 v[40:41], v7 offset:46080
    s_movk_i32 s40, 768
    s_add_u32 m0, s37, 32768
    s_nop 0
    buffer_load_dwordx4 v2, s[8:11], s40 offen lds
    s_cmp_eq_u32 s6, 1
    s_cbranch_scc0 K1_cs_1_13_1
    v_dot2_f32_bf16 v11, v72, v10, v11
    v_dot2_f32_bf16 v12, v73, v10, v12
    v_dot2_f32_bf16 v11, v74, v10, v11
    v_dot2_f32_bf16 v12, v75, v10, v12
K1_cs_1_13_1:
    v_mfma_f32_32x32x16_bf16 v[128:143], v[76:79], v[64:67], v[128:143]
    ds_read_b64_tr_b16 v[42:43], v7 offset:46336
    ds_read_b64_tr_b16 v[44:45], v8 offset:17408
    s_add_u32 m0, s37, 33792
    s_nop 0
    buffer_load_dwordx4 v3, s[8:11], s40 offen lds
    s_cmp_eq_u32 s6, 2
    s_cbranch_scc0 K1_cs_1_13_2
    v_dot2_f32_bf16 v11, v76, v10, v11
    v_dot2_f32_bf16 v12, v77, v10, v12
    v_dot2_f32_bf16 v11, v78, v10, v11
    v_dot2_f32_bf16 v12, v79, v10, v12
K1_cs_1_13_2:
    v_mfma_f32_32x32x16_bf16 v[144:159], v[64:67], v[64:67], v[144:159]
    ds_read_b64_tr_b16 v[46:47], v8 offset:17664
    ds_read_b128 v[48:51], v6 offset:0
    v_mfma_f32_32x32x16_bf16 v[96:111], v[84:87], v[80:83], v[96:111]
    ds_read_b64_tr_b16 v[52:53], v7 offset:19456
    ds_read_b64_tr_b16 v[54:55], v7 offset:19712
    s_cmp_eq_u32 s6, 0
    s_cbranch_scc0 K1_cs_1_15_0
    v_dot2_f32_bf16 v11, v84, v10, v11
    v_dot2_f32_bf16 v12, v85, v10, v12
    v_dot2_f32_bf16 v11, v86, v10, v11
    v_dot2_f32_bf16 v12, v87, v10, v12
K1_cs_1_15_0:
    v_mfma_f32_32x32x16_bf16 v[112:127], v[88:91], v[80:83], v[112:127]
    ds_read_b64_tr_b16 v[56:57], v7 offset:48128
    ds_read_b64_tr_b16 v[58:59], v7 offset:48384
    s_cmp_eq_u32 s6, 1
    s_cbranch_scc0 K1_cs_1_15_1
    v_dot2_f32_bf16 v11, v88, v10, v11
    v_dot2_f32_bf16 v12, v89, v10, v12
    v_dot2_f32_bf16 v11, v90, v10, v11
    v_dot2_f32_bf16 v12, v91, v10, v12
K1_cs_1_15_1:
    v_mfma_f32_32x32x16_bf16 v[128:143], v[92:95], v[80:83], v[128:143]
    ds_read_b64_tr_b16 v[60:61], v8 offset:19456
    ds_read_b64_tr_b16 v[62:63], v8 offset:19712
    s_cmp_eq_u32 s6, 2
    s_cbranch_scc0 K1_cs_1_15_2
    v_dot2_f32_bf16 v11, v92, v10, v11
    v_dot2_f32_bf16 v12, v93, v10, v12
    v_dot2_f32_bf16 v11, v94, v10, v11
    v_dot2_f32_bf16 v12, v95, v10, v12
K1_cs_1_15_2:
    v_mfma_f32_32x32x16_bf16 v[144:159], v[80:83], v[80:83], v[144:159]
    s_waitcnt vmcnt(3)
    ds_write_b16 v14, v10 offset:20480
    s_waitcnt lgkmcnt(0)
    s_barrier
    v_mfma_f32_32x32x16_bf16 v[96:111], v[36:39], v[32:35], v[96:111]
    ds_read_b128 v[64:67], v5 offset:16384
    ds_read_b64_tr_b16 v[68:69], v7 offset:21504
    s_cmp_eq_u32 s6, 0
    s_cbranch_scc0 K1_cs_1_17_0
    v_dot2_f32_bf16 v11, v36, v10, v11
    v_dot2_f32_bf16 v12, v37, v10, v12
    v_dot2_f32_bf16 v11, v38, v10, v11
    v_dot2_f32_bf16 v12, v39, v10, v12
K1_cs_1_17_0:
    v_mfma_f32_32x32x16_bf16 v[112:127], v[40:43], v[32:35], v[112:127]
    ds_read_b64_tr_b16 v[70:71], v7 offset:21760
    ds_read_b64_tr_b16 v[72:73], v7 offset:50176
    s_cmp_eq_u32 s6, 1
    s_cbranch_scc0 K1_cs_1_17_1
    v_dot2_f32_bf16 v11, v40, v10, v11
    v_dot2_f32_bf16 v12, v41, v10, v12
    v_dot2_f32_bf16 v11, v42, v10, v11
    v_dot2_f32_bf16 v12, v43, v10, v12
K1_cs_1_17_1:
    v_mfma_f32_32x32x16_bf16 v[128:143], v[44:47], v[32:35], v[128:143]
    ds_read_b64_tr_b16 v[74:75], v7 offset:50432
    ds_read_b64_tr_b16 v[76:77], v8 offset:21504
    s_cmp_eq_u32 s6, 2
    s_cbranch_scc0 K1_cs_1_17_2
    v_dot2_f32_bf16 v11, v44, v10, v11
    v_dot2_f32_bf16 v12, v45, v10, v12
    v_dot2_f32_bf16 v11, v46, v10, v11
    v_dot2_f32_bf16 v12, v47, v10, v12
K1_cs_1_17_2:
    v_mfma_f32_32x32x16_bf16 v[144:159], v[32:35], v[32:35], v[144:159]
    ds_read_b64_tr_b16 v[78:79], v8 offset:21760
    ds_read_b128 v[80:83], v6 offset:16384
    v_mfma_f32_32x32x16_bf16 v[96:111], v[52:55], v[48:51], v[96:111]
    ds_read_b64_tr_b16 v[84:85], v7 offset:23552
    ds_read_b64_tr_b16 v[86:87], v7 offset:23808
    s_cmp_eq_u32 s6, 0
    s_cbranch_scc0 K1_cs_1_19_0
    v_dot2_f32_bf16 v11, v52, v10, v11
    v_dot2_f32_bf16 v12, v53, v10, v12
    v_dot2_f32_bf16 v11, v54, v10, v11
    v_dot2_f32_bf16 v12, v55, v10, v12
K1_cs_1_19_0:
    v_mfma_f32_32x32x16_bf16 v[112:127], v[56:59], v[48:51], v[112:127]
    ds_read_b64_tr_b16 v[88:89], v7 offset:52224
    ds_read_b64_tr_b16 v[90:91], v7 offset:52480
    s_cmp_eq_u32 s6, 1
    s_cbranch_scc0 K1_cs_1_19_1
    v_dot2_f32_bf16 v11, v56, v10, v11
    v_dot2_f32_bf16 v12, v57, v10, v12
    v_dot2_f32_bf16 v11, v58, v10, v11
    v_dot2_f32_bf16 v12, v59, v10, v12
K1_cs_1_19_1:
    v_mfma_f32_32x32x16_bf16 v[128:143], v[60:63], v[48:51], v[128:143]
    ds_read_b64_tr_b16 v[92:93], v8 offset:23552
    ds_read_b64_tr_b16 v[94:95], v8 offset:23808
    s_cmp_eq_u32 s6, 2
    s_cbranch_scc0 K1_cs_1_19_2
    v_dot2_f32_bf16 v11, v60, v10, v11
    v_dot2_f32_bf16 v12, v61, v10, v12
    v_dot2_f32_bf16 v11, v62, v10, v11
    v_dot2_f32_bf16 v12, v63, v10, v12
K1_cs_1_19_2:
    v_mfma_f32_32x32x16_bf16 v[144:159], v[48:51], v[48:51], v[144:159]
    s_mov_b32 s59, 0x00020000
    s_mov_b32 s63, 0x00020000
    s_mov_b32 s58, 0x188000
    s_mov_b32 s62, 0x188000
    s_cmp_ge_u32 s2, 224
    s_cbranch_scc1 SL1_wo
    s_cmp_ge_u32 s2, 112
    s_cbranch_scc1 SL1_dn
    v_lshrrev_b32 v216, 3, v1
    v_and_b32 v217, 7, v1
    v_lshlrev_b32 v217, 4, v217
    s_lshr_b32 s40, s2, 2
    s_lshl_b32 s40, s40, 7
    v_add_u32 v217, s40, v217
    s_and_b32 s41, s2, 3
    s_mul_i32 s41, s41, 56
    s_and_b32 s42, s3, 3
    s_cmp_ge_u32 s3, 4
    s_cselect_b32 s56, s60, s56
    s_cselect_b32 s57, s61, s57
    s_mov_b32 s43, 135168
    s_cselect_b32 s43, 57344, s43
    s_movk_i32 s46, 4682
    s_movk_i32 s47, 3584
    s_add_u32 s44, s42, 0
    s_lshr_b32 s45, s44, 1
    s_lshl_b32 s45, s45, 3
    s_add_u32 s45, s45, s41
    v_add_u32 v218, s45, v216
    v_mul_u32_u24 v219, s46, v218
    v_lshrrev_b32 v219, 16, v219
    v_mad_u32_u24 v218, v219, 14, v218
    v_mad_u32_u24 v218, v218, s47, v217
    s_and_b32 s45, s44, 1
    s_mul_i32 s45, s45, 50176
    s_lshl_b32 s44, s44, 10
    s_add_u32 m0, s43, s44
    s_nop 0
    buffer_load_dwordx4 v218, s[56:59], s45 offen lds
    s_add_u32 s44, s42, 4
    s_lshr_b32 s45, s44, 1
    s_lshl_b32 s45, s45, 3
    s_add_u32 s45, s45, s41
    v_add_u32 v218, s45, v216
    v_mul_u32_u24 v219, s46, v218
    v_lshrrev_b32 v219, 16, v219
    v_mad_u32_u24 v218, v219, 14, v218
    v_mad_u32_u24 v218, v218, s47, v217
    s_and_b32 s45, s44, 1
    s_mul_i32 s45, s45, 50176
    s_lshl_b32 s44, s44, 10
    s_add_u32 m0, s43, s44
    s_nop 0
    buffer_load_dwordx4 v218, s[56:59], s45 offen lds
    s_add_u32 s44, s42, 8
    s_lshr_b32 s45, s44, 1
    s_lshl_b32 s45, s45, 3
    s_add_u32 s45, s45, s41
    v_add_u32 v218, s45, v216
    v_mul_u32_u24 v219, s46, v218
    v_lshrrev_b32 v219, 16, v219
    v_mad_u32_u24 v218, v219, 14, v218
    v_mad_u32_u24 v218, v218, s47, v217
    s_and_b32 s45, s44, 1
    s_mul_i32 s45, s45, 50176
    s_lshl_b32 s44, s44, 10
    s_add_u32 m0, s43, s44
    s_nop 0
    buffer_load_dwordx4 v218, s[56:59], s45 offen lds
    s_add_u32 s44, s42, 12
    s_cmp_ge_u32 s42, 2
    s_cselect_b32 s44, s42, s44
    s_lshr_b32 s45, s44, 1
    s_lshl_b32 s45, s45, 3
    s_add_u32 s45, s45, s41
    v_add_u32 v218, s45, v216
    v_mul_u32_u24 v219, s46, v218
    v_lshrrev_b32 v219, 16, v219
    v_mad_u32_u24 v218, v219, 14, v218
    v_mad_u32_u24 v218, v218, s47, v217
    s_and_b32 s45, s44, 1
    s_mul_i32 s45, s45, 50176
    s_lshl_b32 s44, s44, 10
    s_add_u32 m0, s43, s44
    s_nop 0
    buffer_load_dwordx4 v218, s[56:59], s45 offen lds
    s_branch SL1_end
SL1_dn:
    v_lshlrev_b32 v216, 4, v1
    s_sub_u32 s40, s2, 112
    s_mul_i32 s40, s40, 14336
    s_lshl_b32 s41, s3, 10
    s_add_u32 s40, s40, s41
    s_add_u32 m0, s41, 135168
    s_nop 0
    buffer_load_dwordx4 v216, s[56:59], s40 offen lds
    s_cmp_ge_u32 s3, 6
    s_cselect_b32 s42, 0, 8192
    s_add_u32 s40, s40, s42
    s_add_u32 s41, s41, s42
    s_add_u32 m0, s41, 135168
    s_nop 0
    buffer_load_dwordx4 v216, s[56:59], s40 offen lds
    buffer_load_dwordx4 v216, s[56:59], s40 offen lds
    buffer_load_dwordx4 v216, s[56:59], s40 offen lds
    s_branch SL1_end
SL1_wo:
    s_mov_b32 s58, 0x62000
    v_lshrrev_b32 v216, 5, v1
    v_bfe_u32 v217, v1, 1, 4
    v_and_b32 v218, 1, v1
    v_mul_u32_u24 v216, 896, v216
    v_mad_u32_u24 v216, v217, 28, v216
    v_lshl_add_u32 v216, v218, 4, v216
    s_sub_u32 s40, s2, 224
    s_lshr_b32 s41, s40, 1
    s_mul_i32 s41, s41, 25088
    s_and_b32 s40, s40, 1
    s_mul_i32 s40, s40, 448
    s_add_u32 s40, s40, s41
    s_mul_i32 s41, s3, 1792
    s_add_u32 s40, s40, s41
    s_lshl_b32 s41, s3, 10
    s_add_u32 m0, s41, 135168
    s_nop 0
    buffer_load_dwordx4 v216, s[56:59], s40 offen lds
    s_cmp_ge_u32 s3, 6
    s_cselect_b32 s42, 0, 14336
    s_cselect_b32 s43, 0, 8192
    s_add_u32 s40, s40, s42
    s_add_u32 s41, s41, s43
    s_add_u32 m0, s41, 135168
    s_nop 0
    buffer_load_dwordx4 v216, s[56:59], s40 offen lds
    buffer_load_dwordx4 v216, s[56:59], s40 offen lds
    buffer_load_dwordx4 v216, s[56:59], s40 offen lds
SL1_end:
    s_nop 4
    s_waitcnt vmcnt(4)
    ds_write_b16 v14, v10 offset:24576
    s_waitcnt lgkmcnt(0)
    s_barrier
    v_mfma_f32_32x32x16_bf16 v[96:111], v[68:71], v[64:67], v[96:111]
    ds_read_b128 v[32:35], v5 offset:32768
    ds_read_b64_tr_b16 v[36:37], v7 offset:25600
    s_cmp_eq_u32 s6, 0
    s_cbranch_scc0 K1_cs_1_21_0
    v_dot2_f32_bf16 v11, v68, v10, v11
    v_dot2_f32_bf16 v12, v69, v10, v12
    v_dot2_f32_bf16 v11, v70, v10, v11
    v_dot2_f32_bf16 v12, v71, v10, v12
K1_cs_1_21_0:
    v_mfma_f32_32x32x16_bf16 v[112:127], v[72:75], v[64:67], v[112:127]
    ds_read_b64_tr_b16 v[38:39], v7 offset:25856
    ds_read_b64_tr_b16 v[40:41], v7 offset:54272
    s_cmp_eq_u32 s6, 1
    s_cbranch_scc0 K1_cs_1_21_1
    v_dot2_f32_bf16 v11, v72, v10, v11
    v_dot2_f32_bf16 v12, v73, v10, v12
    v_dot2_f32_bf16 v11, v74, v10, v11
    v_dot2_f32_bf16 v12, v75, v10, v12
K1_cs_1_21_1:
    v_mfma_f32_32x32x16_bf16 v[128:143], v[76:79], v[64:67], v[128:143]
    ds_read_b64_tr_b16 v[42:43], v7 offset:54528
    ds_read_b64_tr_b16 v[44:45], v8 offset:25600
    s_cmp_eq_u32 s6, 2
    s_cbranch_scc0 K1_cs_1_21_2
    v_dot2_f32_bf16 v11, v76, v10, v11
    v_dot2_f32_bf16 v12, v77, v10, v12
    v_dot2_f32_bf16 v11, v78, v10, v11
    v_dot2_f32_bf16 v12, v79, v10, v12
K1_cs_1_21_2:
    v_mfma_f32_32x32x16_bf16 v[144:159], v[64:67], v[64:67], v[144:159]
    ds_read_b64_tr_b16 v[46:47], v8 offset:25856
    ds_read_b128 v[48:51], v6 offset:32768
    v_mfma_f32_32x32x16_bf16 v[96:111], v[84:87], v[80:83], v[96:111]
    ds_read_b64_tr_b16 v[52:53], v7 offset:27648
    ds_read_b64_tr_b16 v[54:55], v7 offset:27904
    s_cmp_eq_u32 s6, 0
    s_cbranch_scc0 K1_cs_1_23_0
    v_dot2_f32_bf16 v11, v84, v10, v11
    v_dot2_f32_bf16 v12, v85, v10, v12
    v_dot2_f32_bf16 v11, v86, v10, v11
    v_dot2_f32_bf16 v12, v87, v10, v12
K1_cs_1_23_0:
    v_mfma_f32_32x32x16_bf16 v[112:127], v[88:91], v[80:83], v[112:127]
    ds_read_b64_tr_b16 v[56:57], v7 offset:56320
    ds_read_b64_tr_b16 v[58:59], v7 offset:56576
    s_cmp_eq_u32 s6, 1
    s_cbranch_scc0 K1_cs_1_23_1
    v_dot2_f32_bf16 v11, v88, v10, v11
    v_dot2_f32_bf16 v12, v89, v10, v12
    v_dot2_f32_bf16 v11, v90, v10, v11
    v_dot2_f32_bf16 v12, v91, v10, v12
K1_cs_1_23_1:
    v_mfma_f32_32x32x16_bf16 v[128:143], v[92:95], v[80:83], v[128:143]
    ds_read_b64_tr_b16 v[60:61], v8 offset:27648
    ds_read_b64_tr_b16 v[62:63], v8 offset:27904
    s_cmp_eq_u32 s6, 2
    s_cbranch_scc0 K1_cs_1_23_2
    v_dot2_f32_bf16 v11, v92, v10, v11
    v_dot2_f32_bf16 v12, v93, v10, v12
    v_dot2_f32_bf16 v11, v94, v10, v11
    v_dot2_f32_bf16 v12, v95, v10, v12
K1_cs_1_23_2:
    v_mfma_f32_32x32x16_bf16 v[144:159], v[80:83], v[80:83], v[144:159]
    s_waitcnt lgkmcnt(0)
    v_mfma_f32_32x32x16_bf16 v[96:111], v[36:39], v[32:35], v[96:111]
    s_cmp_eq_u32 s6, 0
    s_cbranch_scc0 K1_cs_1_25_0
    v_dot2_f32_bf16 v11, v36, v10, v11
    v_dot2_f32_bf16 v12, v37, v10, v12
    v_dot2_f32_bf16 v11, v38, v10, v11
    v_dot2_f32_bf16 v12, v39, v10, v12
K1_cs_1_25_0:
    v_mfma_f32_32x32x16_bf16 v[112:127], v[40:43], v[32:35], v[112:127]
    s_cmp_eq_u32 s6, 1
    s_cbranch_scc0 K1_cs_1_25_1
    v_dot2_f32_bf16 v11, v40, v10, v11
    v_dot2_f32_bf16 v12, v41, v10, v12
    v_dot2_f32_bf16 v11, v42, v10, v11
    v_dot2_f32_bf16 v12, v43, v10, v12
K1_cs_1_25_1:
    v_mfma_f32_32x32x16_bf16 v[128:143], v[44:47], v[32:35], v[128:143]
    s_cmp_eq_u32 s6, 2
    s_cbranch_scc0 K1_cs_1_25_2
    v_dot2_f32_bf16 v11, v44, v10, v11
    v_dot2_f32_bf16 v12, v45, v10, v12
    v_dot2_f32_bf16 v11, v46, v10, v11
    v_dot2_f32_bf16 v12, v47, v10, v12
K1_cs_1_25_2:
    v_mfma_f32_32x32x16_bf16 v[144:159], v[32:35], v[32:35], v[144:159]
    v_mfma_f32_32x32x16_bf16 v[96:111], v[52:55], v[48:51], v[96:111]
    s_cmp_eq_u32 s6, 0
    s_cbranch_scc0 K1_cs_1_27_0
    v_dot2_f32_bf16 v11, v52, v10, v11
    v_dot2_f32_bf16 v12, v53, v10, v12
    v_dot2_f32_bf16 v11, v54, v10, v11
    v_dot2_f32_bf16 v12, v55, v10, v12
K1_cs_1_27_0:
    v_mfma_f32_32x32x16_bf16 v[112:127], v[56:59], v[48:51], v[112:127]
    s_cmp_eq_u32 s6, 1
    s_cbranch_scc0 K1_cs_1_27_1
    v_dot2_f32_bf16 v11, v56, v10, v11
    v_dot2_f32_bf16 v12, v57, v10, v12
    v_dot2_f32_bf16 v11, v58, v10, v11
    v_dot2_f32_bf16 v12, v59, v10, v12
K1_cs_1_27_1:
    v_mfma_f32_32x32x16_bf16 v[128:143], v[60:63], v[48:51], v[128:143]
    s_cmp_eq_u32 s6, 2
    s_cbranch_scc0 K1_cs_1_27_2
    v_dot2_f32_bf16 v11, v60, v10, v11
    v_dot2_f32_bf16 v12, v61, v10, v12
    v_dot2_f32_bf16 v11, v62, v10, v11
    v_dot2_f32_bf16 v12, v63, v10, v12
K1_cs_1_27_2:
    v_mfma_f32_32x32x16_bf16 v[144:159], v[48:51], v[48:51], v[144:159]
    s_mul_i32 s32, s6, 6144
    v_lshlrev_b32 v19, 4, v1
    v_add_u32 v18, s32, v19
    ds_write_b128 v18, v[96:99] offset:28672
    ds_write_b128 v18, v[100:103] offset:29696
    ds_write_b128 v18, v[104:107] offset:30720
    ds_write_b128 v18, v[108:111] offset:31744
    s_nop 1
    ds_write_b128 v18, v[128:131] offset:32768
    ds_write_b128 v18, v[132:135] offset:33792
    v_add_f32 v11, v11, v12
    v_mov_b32 v12, v11
    s_nop 1
    v_permlane32_swap_b32 v11, v12
    v_add_f32 v11, v11, v12
    v_and_b32 v17, 31, v1
    s_lshl_b32 s32, s6, 8
    s_add_u32 s32, s32, 153728
    v_lshl_add_u32 v17, v17, 2, s32
    ds_write_b32 v17, v11
    v_and_b32 v15, 31, v1
    v_and_b32 v16, 3, v1
    v_bfe_u32 v17, v1, 3, 2
    v_cmp_eq_u32 s[42:43], 1, v16
    v_cmp_eq_u32 s[44:45], 2, v16
    v_cmp_eq_u32 s[46:47], 3, v16
    v_cmp_eq_u32 s[50:51], 1, v17
    v_cmp_eq_u32 s[52:53], 2, v17
    v_cmp_eq_u32 s[54:55], 3, v17
    v_cndmask_b32 v144, v144, v145, s[42:43]
    v_cndmask_b32 v144, v144, v146, s[44:45]
    v_cndmask_b32 v144, v144, v147, s[46:47]
    v_cndmask_b32 v148, v148, v149, s[42:43]
    v_cndmask_b32 v148, v148, v150, s[44:45]
    v_cndmask_b32 v148, v148, v151, s[46:47]
    v_cndmask_b32 v152, v152, v153, s[42:43]
    v_cndmask_b32 v152, v152, v154, s[44:45]
    v_cndmask_b32 v152, v152, v155, s[46:47]
    v_cndmask_b32 v156, v156, v157, s[42:43]
    v_cndmask_b32 v156, v156, v158, s[44:45]
    v_cndmask_b32 v156, v156, v159, s[46:47]
    v_cndmask_b32 v144, v144, v148, s[50:51]
    v_cndmask_b32 v144, v144, v152, s[52:53]
    v_cndmask_b32 v144, v144, v156, s[54:55]
    s_lshl_b32 s32, s6, 5
    v_add_u32 v16, s32, v15
    v_lshlrev_b32 v17, 3, v16
    v_add_u32 v17, 151552, v17
    s_mov_b32 exec_lo, 0
    ds_write_b32 v17, v140 offset:1024
    s_mov_b32 exec_lo, 0x0f0f0f0f
    s_mov_b32 exec_hi, 0xf0f0f0f0
    ds_write_b32 v17, v144 offset:1028
    s_mov_b64 exec, -1
    s_waitcnt vmcnt(0) lgkmcnt(0)
    s_barrier
    s_setprio 1
    ds_read_b128 v[32:35], v18 offset:0
    ds_read_b128 v[36:39], v18 offset:1024
    ds_read_b128 v[40:43], v18 offset:2048
    ds_read_b128 v[44:47], v18 offset:3072
    ds_read_b128 v[48:51], v18 offset:4096
    ds_read_b128 v[52:55], v18 offset:5120
    ds_read_b64 v[10:11], v17
    ds_read_b64 v[12:13], v17 offset:1024
    v_lshrrev_b32 v18, 5, v1
    v_lshlrev_b32 v18, 4, v18
    v_add_u32 v18, 153600, v18
    ds_read_b128 v[144:147], v18 offset:256
    ds_read_b128 v[148:151], v18 offset:288
    ds_read_b128 v[152:155], v18 offset:320
    ds_read_b128 v[156:159], v18 offset:352
    ds_read_b128 v[160:163], v18 offset:576
    ds_read_b128 v[164:167], v18 offset:608
    ds_read_b128 v[168:171], v18 offset:384
    ds_read_b128 v[172:175], v18 offset:416
    ds_read_b128 v[176:179], v18 offset:448
    ds_read_b128 v[180:183], v18 offset:480
    ds_read_b128 v[184:187], v18 offset:704
    ds_read_b128 v[188:191], v18 offset:736
    s_waitcnt lgkmcnt(12)
    v_add_f32 v10, v10, v12
    v_add_f32 v11, v11, v13
    v_mul_f32 v10, 0xbb124925, v10
    v_mul_f32 v11, 0x3b124925, v11
    v_fma_f32 v11, -v10, v10, v11
    v_max_f32 v11, 0, v11
    v_add_f32 v11, 0x3727c5ac, v11
    v_rsq_f32 v11, v11
    v_add_f32 v112, v112, v32
    v_add_f32 v113, v113, v33
    v_add_f32 v114, v114, v34
    v_add_f32 v115, v115, v35
    v_add_f32 v116, v116, v36
    v_add_f32 v117, v117, v37
    v_add_f32 v118, v118, v38
    v_add_f32 v119, v119, v39
    v_add_f32 v120, v120, v40
    v_add_f32 v121, v121, v41
    v_add_f32 v122, v122, v42
    v_add_f32 v123, v123, v43
    v_add_f32 v124, v124, v44
    v_add_f32 v125, v125, v45
    v_add_f32 v126, v126, v46
    v_add_f32 v127, v127, v47
    v_add_f32 v136, v136, v48
    v_add_f32 v137, v137, v49
    v_add_f32 v138, v138, v50
    v_add_f32 v139, v139, v51
    v_add_f32 v140, v140, v52
    v_add_f32 v141, v141, v53
    v_add_f32 v142, v142, v54
    v_add_f32 v143, v143, v55
    s_waitcnt lgkmcnt(0)
    ds_read_u16 v20, v28 offset:0
    ds_read_u16 v208, v28 offset:56
    ds_read_u16 v21, v28 offset:112
    ds_read_u16 v209, v28 offset:168
    ds_read_u16 v22, v28 offset:448
    ds_read_u16 v210, v28 offset:504
    ds_read_u16 v23, v28 offset:560
    ds_read_u16 v211, v28 offset:616
    ds_read_u16 v24, v28 offset:896
    ds_read_u16 v212, v28 offset:952
    ds_read_u16 v25, v28 offset:1008
    ds_read_u16 v213, v28 offset:1064
    ds_read_u16 v26, v28 offset:1344
    ds_read_u16 v214, v28 offset:1400
    ds_read_u16 v27, v28 offset:1456
    ds_read_u16 v215, v28 offset:1512
    v_add_f32 v144, v144, v168
    v_add_f32 v145, v145, v169
    v_add_f32 v146, v146, v170
    v_add_f32 v147, v147, v171
    v_add_f32 v148, v148, v172
    v_add_f32 v149, v149, v173
    v_add_f32 v150, v150, v174
    v_add_f32 v151, v151, v175
    v_add_f32 v152, v152, v176
    v_add_f32 v153, v153, v177
    v_add_f32 v154, v154, v178
    v_add_f32 v155, v155, v179
    v_add_f32 v156, v156, v180
    v_add_f32 v157, v157, v181
    v_add_f32 v158, v158, v182
    v_add_f32 v159, v159, v183
    v_add_f32 v160, v160, v184
    v_add_f32 v161, v161, v185
    v_add_f32 v162, v162, v186
    v_add_f32 v163, v163, v187
    v_add_f32 v164, v164, v188
    v_add_f32 v165, v165, v189
    v_add_f32 v166, v166, v190
    v_add_f32 v167, v167, v191
    v_fmac_f32 v112, v10, v144
    v_fmac_f32 v113, v10, v145
    v_fmac_f32 v114, v10, v146
    v_fmac_f32 v115, v10, v147
    v_fmac_f32 v116, v10, v148
    v_fmac_f32 v117, v10, v149
    v_fmac_f32 v118, v10, v150
    v_fmac_f32 v119, v10, v151
    v_fmac_f32 v120, v10, v152
    v_fmac_f32 v121, v10, v153
    v_fmac_f32 v122, v10, v154
    v_fmac_f32 v123, v10, v155
    v_fmac_f32 v124, v10, v156
    v_fmac_f32 v125, v10, v157
    v_fmac_f32 v126, v10, v158
    v_fmac_f32 v127, v10, v159
    v_fmac_f32 v136, v10, v160
    v_fmac_f32 v137, v10, v161
    v_fmac_f32 v138, v10, v162
    v_fmac_f32 v139, v10, v163
    v_fmac_f32 v140, v10, v164
    v_fmac_f32 v141, v10, v165
    v_fmac_f32 v142, v10, v166
    v_fmac_f32 v143, v10, v167
    v_mul_f32 v136, v136, v11
    v_mul_f32 v137, v137, v11
    v_mul_f32 v138, v138, v11
    v_mul_f32 v139, v139, v11
    v_mul_f32 v140, v140, v11
    v_mul_f32 v141, v141, v11
    v_mul_f32 v142, v142, v11
    v_mul_f32 v143, v143, v11
    v_mul_f32 v13, s36, v11
    v_cvt_pk_bf16_f32 v32, v112, v113
    v_cvt_pk_bf16_f32 v33, v114, v115
    v_cvt_pk_bf16_f32 v34, v116, v117
    v_cvt_pk_bf16_f32 v35, v118, v119
    v_cvt_pk_bf16_f32 v36, v120, v121
    v_cvt_pk_bf16_f32 v37, v122, v123
    v_cvt_pk_bf16_f32 v38, v124, v125
    v_cvt_pk_bf16_f32 v39, v126, v127
    s_mov_b32 s44, 0x33ffffff
    s_mov_b32 s45, 0x33ffffff
    s_mov_b32 s46, 0x33ffffff
    s_mov_b32 s47, 0
    s_waitcnt lgkmcnt(0)
    v_lshl_or_b32 v20, v208, 16, v20
    v_lshl_or_b32 v21, v209, 16, v21
    v_lshl_or_b32 v22, v210, 16, v22
    v_lshl_or_b32 v23, v211, 16, v23
    v_lshl_or_b32 v24, v212, 16, v24
    v_lshl_or_b32 v25, v213, 16, v25
    v_lshl_or_b32 v26, v214, 16, v26
    v_lshl_or_b32 v27, v215, 16, v27
    v_cndmask_b32 v20, 0, v20, s[44:45]
    v_cndmask_b32 v21, 0, v21, s[44:45]
    v_cndmask_b32 v22, 0, v22, s[44:45]
    v_cndmask_b32 v23, 0, v23, s[44:45]
    v_cndmask_b32 v24, 0, v24, s[44:45]
    v_cndmask_b32 v25, 0, v25, s[44:45]
    v_cndmask_b32 v26, 0, v26, s[46:47]
    v_cndmask_b32 v27, 0, v27, s[46:47]
    v_mfma_f32_32x32x16_bf16 v[144:159], v[20:23], v[32:35], 0
    s_nop 0
    v_mfma_f32_32x32x16_bf16 v[144:159], v[24:27], v[36:39], v[144:159]
    v_mul_u32_u24 v19, 192, v16
    v_lshrrev_b32 v18, 5, v1
    v_add_u32 v19, 86016, v19
    v_lshl_add_u32 v17, v18, 3, v19
    v_lshl_add_u32 v19, v18, 5, v19
    v_cvt_pk_bf16_f32 v40, v136, v137
    v_cvt_pk_bf16_f32 v41, v138, v139
    v_cvt_pk_bf16_f32 v42, v140, v141
    v_cvt_pk_bf16_f32 v43, v142, v143
    ds_write_b64 v17, v[40:41] offset:160
    s_nop 0
    v_permlane32_swap_b32 v42, v43
    v_mov_b32 v43, 0x3f80
    ds_write_b64 v17, v[42:43] offset:176
    s_lshl_b32 s33, s5, 2
    v_mov_b32 v31, 0
    buffer_load_dword v30, v31, s[20:23], s33 offen sc1
    v_max3_f32 v168, v144, v145, v146
    v_min3_f32 v169, v144, v145, v146
    v_max3_f32 v168, v168, v147, v148
    v_min3_f32 v169, v169, v147, v148
    v_max3_f32 v168, v168, v149, v150
    v_min3_f32 v169, v169, v149, v150
    v_max3_f32 v168, v168, v151, v152
    v_min3_f32 v169, v169, v151, v152
    v_max3_f32 v168, v168, v153, v154
    v_min3_f32 v169, v169, v153, v154
    v_max3_f32 v168, v168, v155, v156
    v_min3_f32 v169, v169, v155, v156
    v_max_f32 v168, v168, v157
    v_min_f32 v169, v169, v157
    v_mov_b32 v170, v168
    v_mov_b32 v171, v169
    s_nop 0
    v_permlane32_swap_b32 v168, v170
    v_permlane32_swap_b32 v169, v171
    v_max_f32 v168, v168, v170
    v_min_f32 v169, v169, v171
    v_mul_f32 v168, v13, v168
    v_mul_f32 v169, v13, v169
    v_fma_f32 v174, v144, v13, -v168
    v_fma_f32 v188, -v144, v13, v169
    v_fma_f32 v175, v145, v13, -v168
    v_fma_f32 v189, -v145, v13, v169
    v_fma_f32 v176, v146, v13, -v168
    v_fma_f32 v190, -v146, v13, v169
    v_fma_f32 v177, v147, v13, -v168
    v_fma_f32 v191, -v147, v13, v169
    v_fma_f32 v178, v148, v13, -v168
    v_fma_f32 v192, -v148, v13, v169
    v_fma_f32 v179, v149, v13, -v168
    v_fma_f32 v193, -v149, v13, v169
    v_fma_f32 v180, v150, v13, -v168
    v_fma_f32 v194, -v150, v13, v169
    v_fma_f32 v181, v151, v13, -v168
    v_fma_f32 v195, -v151, v13, v169
    v_fma_f32 v182, v152, v13, -v168
    v_fma_f32 v196, -v152, v13, v169
    v_fma_f32 v183, v153, v13, -v168
    v_fma_f32 v197, -v153, v13, v169
    v_fma_f32 v184, v154, v13, -v168
    v_fma_f32 v198, -v154, v13, v169
    v_fma_f32 v185, v155, v13, -v168
    v_fma_f32 v199, -v155, v13, v169
    v_fma_f32 v186, v156, v13, -v168
    v_fma_f32 v200, -v156, v13, v169
    v_fma_f32 v187, v157, v13, -v168
    v_fma_f32 v201, -v157, v13, v169
    v_exp_f32 v174, v174
    v_exp_f32 v188, v188
    v_exp_f32 v175, v175
    v_exp_f32 v189, v189
    v_exp_f32 v176, v176
    v_exp_f32 v190, v190
    v_exp_f32 v177, v177
    v_exp_f32 v191, v191
    v_exp_f32 v178, v178
    v_exp_f32 v192, v192
    v_exp_f32 v179, v179
    v_exp_f32 v193, v193
    v_exp_f32 v180, v180
    v_exp_f32 v194, v194
    v_exp_f32 v181, v181
    v_exp_f32 v195, v195
    v_exp_f32 v182, v182
    v_exp_f32 v196, v196
    v_exp_f32 v183, v183
    v_exp_f32 v197, v197
    v_exp_f32 v184, v184
    v_exp_f32 v198, v198
    v_exp_f32 v185, v185
    v_exp_f32 v199, v199
    v_exp_f32 v186, v186
    v_exp_f32 v200, v200
    v_exp_f32 v187, v187
    v_exp_f32 v201, v201
    v_add_f32 v172, v174, v175
    v_add_f32 v173, v188, v189
    v_add_f32 v172, v172, v176
    v_add_f32 v173, v173, v190
    v_add_f32 v172, v172, v177
    v_add_f32 v173, v173, v191
    v_add_f32 v172, v172, v178
    v_add_f32 v173, v173, v192
    v_add_f32 v172, v172, v179
    v_add_f32 v173, v173, v193
    v_add_f32 v172, v172, v180
    v_add_f32 v173, v173, v194
    v_add_f32 v172, v172, v181
    v_add_f32 v173, v173, v195
    v_add_f32 v172, v172, v182
    v_add_f32 v173, v173, v196
    v_add_f32 v172, v172, v183
    v_add_f32 v173, v173, v197
    v_add_f32 v172, v172, v184
    v_add_f32 v173, v173, v198
    v_add_f32 v172, v172, v185
    v_add_f32 v173, v173, v199
    v_add_f32 v172, v172, v186
    v_add_f32 v173, v173, v200
    v_add_f32 v172, v172, v187
    v_add_f32 v173, v173, v201
    v_mov_b32 v170, v172
    v_mov_b32 v171, v173
    s_nop 0
    v_permlane32_swap_b32 v172, v170
    v_permlane32_swap_b32 v173, v171
    v_add_f32 v172, v172, v170
    v_add_f32 v173, v173, v171
    v_rcp_f32 v172, v172
    v_rcp_f32 v173, v173
    v_mul_f32 v174, v174, v172
    v_mul_f32 v188, v188, v173
    v_mul_f32 v175, v175, v172
    v_mul_f32 v189, v189, v173
    v_mul_f32 v176, v176, v172
    v_mul_f32 v190, v190, v173
    v_mul_f32 v177, v177, v172
    v_mul_f32 v191, v191, v173
    v_mul_f32 v178, v178, v172
    v_mul_f32 v192, v192, v173
    v_mul_f32 v179, v179, v172
    v_mul_f32 v193, v193, v173
    v_mul_f32 v180, v180, v172
    v_mul_f32 v194, v194, v173
    v_mul_f32 v181, v181, v172
    v_mul_f32 v195, v195, v173
    v_mul_f32 v182, v182, v172
    v_mul_f32 v196, v196, v173
    v_mul_f32 v183, v183, v172
    v_mul_f32 v197, v197, v173
    v_mul_f32 v184, v184, v172
    v_mul_f32 v198, v198, v173
    v_mul_f32 v185, v185, v172
    v_mul_f32 v199, v199, v173
    v_mul_f32 v186, v186, v172
    v_mul_f32 v200, v200, v173
    v_mul_f32 v187, v187, v172
    v_mul_f32 v201, v201, v173
    v_cvt_pk_bf16_f32 v48, v174, v175
    v_cvt_pk_bf16_f32 v56, v188, v189
    v_cvt_pk_bf16_f32 v49, v176, v177
    v_cvt_pk_bf16_f32 v57, v190, v191
    v_cvt_pk_bf16_f32 v50, v178, v179
    v_cvt_pk_bf16_f32 v58, v192, v193
    v_cvt_pk_bf16_f32 v51, v180, v181
    v_cvt_pk_bf16_f32 v59, v194, v195
    v_cvt_pk_bf16_f32 v52, v182, v183
    v_cvt_pk_bf16_f32 v60, v196, v197
    v_cvt_pk_bf16_f32 v53, v184, v185
    v_cvt_pk_bf16_f32 v61, v198, v199
    v_cvt_pk_bf16_f32 v54, v186, v187
    v_cvt_pk_bf16_f32 v62, v200, v201
    v_mov_b32 v55, 0
    v_mov_b32 v63, 0
    ds_write_b128 v19, v[48:51]
    ds_write_b128 v19, v[52:55] offset:16
    ds_write_b128 v19, v[56:59] offset:64
    ds_write_b128 v19, v[60:63] offset:80
    v_lshrrev_b32 v15, 5, v1
    v_bfe_u32 v16, v1, 2, 2
    v_lshl_add_u32 v15, v15, 3, v16
    v_mul_u32_u24 v15, 192, v15
    v_add_u32 v15, 86016, v15
    v_bfe_u32 v16, v1, 4, 1
    v_and_b32 v17, 3, v1
    v_lshrrev_b32 v19, 1, v17
    v_lshl_add_u32 v19, v16, 1, v19
    v_and_b32 v14, 1, v17
    v_lshl_add_u32 v19, v14, 2, v19
    v_lshl_add_u32 v2, v19, 3, v15
    s_lshl_b32 s32, s6, 6
    v_add_u32 v2, s32, v2
    v_lshl_add_u32 v3, v16, 5, v15
    v_lshl_add_u32 v3, v17, 3, v3
    s_waitcnt vmcnt(0) lgkmcnt(0)
    s_barrier
    s_cmp_ge_u32 s6, 2
    s_cbranch_scc1 K1_fin
    ds_read_b64_tr_b16 v[64:65], v2 offset:0
    ds_read_b64_tr_b16 v[66:67], v2 offset:768
    ds_read_b64_tr_b16 v[68:69], v3 offset:128
    ds_read_b64_tr_b16 v[70:71], v3 offset:896
    ds_read_b64_tr_b16 v[72:73], v2 offset:3072
    ds_read_b64_tr_b16 v[74:75], v2 offset:3840
    ds_read_b64_tr_b16 v[76:77], v3 offset:3200
    ds_read_b64_tr_b16 v[78:79], v3 offset:3968
    ds_read_b64_tr_b16 v[80:81], v2 offset:6144
    ds_read_b64_tr_b16 v[82:83], v2 offset:6912
    ds_read_b64_tr_b16 v[84:85], v3 offset:6272
    ds_read_b64_tr_b16 v[86:87], v3 offset:7040
    ds_read_b64_tr_b16 v[88:89], v2 offset:9216
    ds_read_b64_tr_b16 v[90:91], v2 offset:9984
    ds_read_b64_tr_b16 v[92:93], v3 offset:9344
    ds_read_b64_tr_b16 v[94:95], v3 offset:10112
    ds_read_b64_tr_b16 v[96:97], v2 offset:12288
    ds_read_b64_tr_b16 v[98:99], v2 offset:13056
    ds_read_b64_tr_b16 v[100:101], v3 offset:12416
    ds_read_b64_tr_b16 v[102:103], v3 offset:13184
    ds_read_b64_tr_b16 v[104:105], v2 offset:15360
    ds_read_b64_tr_b16 v[106:107], v2 offset:16128
    ds_read_b64_tr_b16 v[108:109], v3 offset:15488
    ds_read_b64_tr_b16 v[110:111], v3 offset:16256
    ds_read_b64_tr_b16 v[112:113], v2 offset:18432
    ds_read_b64_tr_b16 v[114:115], v2 offset:19200
    ds_read_b64_tr_b16 v[116:117], v3 offset:18560
    ds_read_b64_tr_b16 v[118:119], v3 offset:19328
    ds_read_b64_tr_b16 v[120:121], v2 offset:21504
    ds_read_b64_tr_b16 v[122:123], v2 offset:22272
    ds_read_b64_tr_b16 v[124:125], v3 offset:21632
    ds_read_b64_tr_b16 v[126:127], v3 offset:22400
    s_lshl_b32 s32, s5, 1
    s_add_u32 s32, s32, s6
    s_lshl_b32 s32, s32, 12
    s_add_u32 s32, s32, 0x400000
    v_lshlrev_b32 v18, 2, v1
    s_waitcnt lgkmcnt(15)
    v_mfma_f32_32x32x16_bf16 v[144:159], v[64:67], v[68:71], 0
    s_waitcnt lgkmcnt(15)
    v_mfma_f32_32x32x16_bf16 v[144:159], v[72:75], v[76:79], v[144:159]
    s_waitcnt lgkmcnt(15)
    v_mfma_f32_32x32x16_bf16 v[144:159], v[80:83], v[84:87], v[144:159]
    s_waitcnt lgkmcnt(15)
    v_mfma_f32_32x32x16_bf16 v[144:159], v[88:91], v[92:95], v[144:159]
    s_waitcnt lgkmcnt(12)
    v_mfma_f32_32x32x16_bf16 v[144:159], v[96:99], v[100:103], v[144:159]
    s_waitcnt lgkmcnt(8)
    v_mfma_f32_32x32x16_bf16 v[144:159], v[104:107], v[108:111], v[144:159]
    s_waitcnt lgkmcnt(4)
    v_mfma_f32_32x32x16_bf16 v[144:159], v[112:115], v[116:119], v[144:159]
    s_waitcnt lgkmcnt(0)
    v_mfma_f32_32x32x16_bf16 v[144:159], v[120:123], v[124:127], v[144:159]
    s_mov_b32 s34, 0
K1_zspin:
    s_waitcnt vmcnt(0)
    v_readfirstlane_b32 s35, v30
    s_nop 0
    s_cmp_lg_u32 s35, 0
    s_cbranch_scc1 K1_zok
    s_sleep 4
    buffer_load_dword v30, v31, s[20:23], s33 offen sc1
    s_add_u32 s34, s34, 1
    s_cmp_lt_u32 s34, 100000
    s_cbranch_scc1 K1_zspin
K1_zok:
    s_nop 7
    buffer_atomic_add_f32 v144, v18, s[24:27], s32 offen offset:0
    buffer_atomic_add_f32 v145, v18, s[24:27], s32 offen offset:256
    buffer_atomic_add_f32 v146, v18, s[24:27], s32 offen offset:512
    buffer_atomic_add_f32 v147, v18, s[24:27], s32 offen offset:768
    buffer_atomic_add_f32 v148, v18, s[24:27], s32 offen offset:1024
    buffer_atomic_add_f32 v149, v18, s[24:27], s32 offen offset:1280
    buffer_atomic_add_f32 v150, v18, s[24:27], s32 offen offset:1536
    buffer_atomic_add_f32 v151, v18, s[24:27], s32 offen offset:1792
    buffer_atomic_add_f32 v152, v18, s[24:27], s32 offen offset:2048
    buffer_atomic_add_f32 v153, v18, s[24:27], s32 offen offset:2304
    buffer_atomic_add_f32 v154, v18, s[24:27], s32 offen offset:2560
    buffer_atomic_add_f32 v155, v18, s[24:27], s32 offen offset:2816
    buffer_atomic_add_f32 v156, v18, s[24:27], s32 offen offset:3072
    buffer_atomic_add_f32 v157, v18, s[24:27], s32 offen offset:3328
    s_branch K1_fin
K1_fin:
K1_done:
    s_endpgm
.globl kb_kernel
.p2align 8
.type kb_kernel,@function
kb_kernel:
    s_cmp_ge_u32 s2, 256
    s_cbranch_scc1 KB_done
    s_load_dwordx2 s[24:25], s[0:1], 80
    s_load_dwordx2 s[20:21], s[0:1], 64
    s_load_dwordx2 s[48:49], s[0:1], 0
    s_mov_b32 s26, 0x2000000
    s_mov_b32 s27, 0x00020000
    s_mov_b32 s22, 0x1c0000
    s_mov_b32 s23, 0x00020000
    s_mov_b32 s50, 0x1c0000
    s_mov_b32 s51, 0x00020000
    v_lshrrev_b32 v1, 6, v0
    s_nop 0
    v_readfirstlane_b32 s3, v1
    v_and_b32 v1, 63, v0
    s_and_b32 s30, s2, 7
    s_lshr_b32 s31, s2, 3
    s_and_b32 s4, s30, 1
    s_lshl_b32 s4, s4, 3
    s_and_b32 s32, s31, 7
    s_add_u32 s4, s4, s32
    s_lshr_b32 s5, s30, 1
    s_lshl_b32 s5, s5, 2
    s_lshr_b32 s32, s31, 3
    s_add_u32 s5, s5, s32
    v_lshlrev_b32 v2, 4, v1
    s_lshl_b32 s6, s4, 2
    s_add_u32 s6, s6, s3
    s_mul_i32 s7, s5, 200704
    s_add_u32 s7, s7, 0x800000
    s_mul_i32 s8, s3, 3072
    s_lshl_b32 s10, s3, 12
    s_add_u32 s11, s7, s8
    s_add_u32 s12, s7, s10
    s_mul_i32 s13, s6, 28672
    s_add_u32 s13, s13, 0x1000000
    v_and_b32 v3, 31, v1
    v_lshlrev_b32 v3, 2, v3
    v_add_u32 v3, 151552, v3
    v_add_u32 v4, 61440, v2
    v_add_u32 v5, 122880, v2
    s_mul_i32 s9, s6, 112
    s_mul_i32 s32, s5, 7
    s_add_u32 s9, s9, s32
    s_lshl_b32 s9, s9, 10
    s_add_u32 s9, s9, 0x1400000
    s_add_u32 s14, s9, 4096
    s_min_u32 s33, s31, 27
    s_mul_i32 s32, s33, 37
    s_lshr_b32 s32, s32, 8
    s_mul_i32 s17, s32, 7
    s_sub_u32 s17, s33, s17
    s_lshl_b32 s16, s30, 2
    s_add_u32 s16, s16, s32
    s_mul_i32 s32, s3, 28672
    s_mul_i32 s40, s16, 229376
    s_add_u32 s40, s40, s32
    s_add_u32 s40, s40, 0x1400000
    s_mul_i32 s41, s17, 229376
    s_add_u32 s41, s41, s32
    s_add_u32 s41, s41, 0xd00000
    s_lshl_b32 s42, s4, 10
    s_add_u32 s42, s42, 0xce0000
    s_lshr_b32 s47, s16, 1
    s_lshl_b32 s47, s47, 10
    s_add_u32 s47, s47, 0xce0000
    v_mov_b32 v9, 0
    s_lshl_b32 s52, s30, 3
    s_lshr_b32 s32, s31, 2
    s_add_u32 s52, s52, s32
    s_and_b32 s53, s31, 3
    s_lshl_b32 s54, s53, 2
    s_add_u32 s54, s54, s3
    s_lshr_b32 s58, s52, 2
    s_and_b32 s59, s31, 15
    s_lshl_b32 s32, s59, 13
    s_lshl_b32 s33, s3, 11
    s_add_u32 s32, s32, s33
    s_add_u32 s32, s32, 0x400000
    s_add_u32 m0, s33, 118784
    s_waitcnt lgkmcnt(0)
    buffer_load_dwordx4 v2, s[24:27], s32 offen lds
    buffer_load_dwordx4 v2, s[24:27], s32 offen offset:1024 lds
    s_lshl_b32 s60, s58, 2
    s_add_u32 s60, s60, s3
    s_lshl_b32 s32, s60, 4
    s_add_u32 s32, s32, s59
    s_lshl_b32 s32, s32, 12
    buffer_load_dwordx4 v[16:19], v2, s[24:27], s32 offen offset:0
    buffer_load_dwordx4 v[20:23], v2, s[24:27], s32 offen offset:1024
    buffer_load_dwordx4 v[24:27], v2, s[24:27], s32 offen offset:2048
    buffer_load_dwordx4 v[28:31], v2, s[24:27], s32 offen offset:3072
    v_lshlrev_b32 v15, 2, v1
    v_add_u32 v15, 118784, v15
    v_and_b32 v12, 31, v1
    s_lshl_b32 s32, s52, 5
    v_add_u32 v12, s32, v12
    v_mul_u32_u24 v12, 896, v12
    v_lshrrev_b32 v13, 5, v1
    v_mad_u32_u24 v12, v13, 28, v12
    s_mul_i32 s34, s54, 56
    v_add_u32 v12, s34, v12
    s_lshl_b32 s57, s54, 15
    s_add_u32 s57, s57, 0x700000
    buffer_load_dwordx4 a[0:3], v2, s[24:27], s57 offen offset:0
    buffer_load_dwordx4 a[4:7], v2, s[24:27], s57 offen offset:1024
    buffer_load_dwordx4 a[8:11], v2, s[24:27], s57 offen offset:2048
    buffer_load_dwordx4 a[12:15], v2, s[24:27], s57 offen offset:3072
    s_add_u32 s57, s57, 4096
    buffer_load_dwordx4 a[16:19], v2, s[24:27], s57 offen offset:0
    buffer_load_dwordx4 a[20:23], v2, s[24:27], s57 offen offset:1024
    v_add_u32 v14, 118784, v2
    s_lshl_b32 s61, s60, 5
    s_lshl_b32 s32, s59, 1
    s_add_u32 s61, s61, s32
    s_lshl_b32 s61, s61, 10
    s_add_u32 s61, s61, 0x1200000
    s_waitcnt vmcnt(10)
    s_barrier
    ds_read2st64_b32 v[80:81], v15 offset0:0 offset1:1
    ds_read2st64_b32 v[82:83], v15 offset0:2 offset1:3
    ds_read2st64_b32 v[84:85], v15 offset0:4 offset1:5
    ds_read2st64_b32 v[86:87], v15 offset0:6 offset1:7
    ds_read2st64_b32 v[88:89], v15 offset0:8 offset1:9
    ds_read2st64_b32 v[90:91], v15 offset0:10 offset1:11
    ds_read2st64_b32 v[92:93], v15 offset0:12 offset1:13
    ds_read2st64_b32 v[94:95], v15 offset0:14 offset1:15
    ds_read2st64_b32 v[96:97], v15 offset0:16 offset1:17
    ds_read2st64_b32 v[98:99], v15 offset0:18 offset1:19
    ds_read2st64_b32 v[100:101], v15 offset0:20 offset1:21
    ds_read2st64_b32 v[102:103], v15 offset0:22 offset1:23
    ds_read2st64_b32 v[104:105], v15 offset0:24 offset1:25
    ds_read2st64_b32 v[106:107], v15 offset0:26 offset1:27
    ds_read2st64_b32 v[108:109], v15 offset0:28 offset1:29
    ds_read2st64_b32 v[110:111], v15 offset0:30 offset1:31
    s_waitcnt vmcnt(6)
    s_waitcnt lgkmcnt(12)
    v_cvt_pk_bf16_f32 v232, v80, v81
    v_cvt_pk_bf16_f32 v233, v82, v83
    v_cvt_pk_bf16_f32 v234, v84, v85
    v_cvt_pk_bf16_f32 v235, v86, v87
    s_nop 1
    v_mfma_f32_32x32x16_bf16 v[144:159], v[232:235], v[16:19], 0
    s_waitcnt lgkmcnt(8)
    v_cvt_pk_bf16_f32 v236, v88, v89
    v_cvt_pk_bf16_f32 v237, v90, v91
    v_cvt_pk_bf16_f32 v238, v92, v93
    v_cvt_pk_bf16_f32 v239, v94, v95
    s_nop 1
    v_mfma_f32_32x32x16_bf16 v[144:159], v[236:239], v[20:23], v[144:159]
    s_waitcnt lgkmcnt(4)
    v_cvt_pk_bf16_f32 v232, v96, v97
    v_cvt_pk_bf16_f32 v233, v98, v99
    v_cvt_pk_bf16_f32 v234, v100, v101
    v_cvt_pk_bf16_f32 v235, v102, v103
    s_nop 1
    v_mfma_f32_32x32x16_bf16 v[144:159], v[232:235], v[24:27], v[144:159]
    s_waitcnt lgkmcnt(0)
    v_cvt_pk_bf16_f32 v236, v104, v105
    v_cvt_pk_bf16_f32 v237, v106, v107
    v_cvt_pk_bf16_f32 v238, v108, v109
    v_cvt_pk_bf16_f32 v239, v110, v111
    s_nop 1
    v_mfma_f32_32x32x16_bf16 v[144:159], v[236:239], v[28:31], v[144:159]
    s_nop 11
    v_add_f32 v6, 0x358637bd, v158
    v_rcp_f32 v6, v6
    s_nop 0
    v_mul_f32 v144, v144, v6
    v_mul_f32 v145, v145, v6
    v_mul_f32 v146, v146, v6
    v_mul_f32 v147, v147, v6
    v_mul_f32 v148, v148, v6
    v_mul_f32 v149, v149, v6
    v_mul_f32 v150, v150, v6
    v_mul_f32 v151, v151, v6
    v_mul_f32 v152, v152, v6
    v_mul_f32 v153, v153, v6
    v_mul_f32 v154, v154, v6
    v_mul_f32 v155, v155, v6
    v_mul_f32 v156, v156, v6
    v_mul_f32 v157, v157, v6
    v_cvt_pk_bf16_f32 v216, v144, v145
    v_cvt_pk_bf16_f32 v217, v146, v147
    v_cvt_pk_bf16_f32 v218, v148, v149
    v_cvt_pk_bf16_f32 v219, v150, v151
    v_cvt_pk_bf16_f32 v220, v152, v153
    v_cvt_pk_bf16_f32 v221, v154, v155
    v_cvt_pk_bf16_f32 v222, v156, v157
    v_mov_b32 v223, 0
    buffer_store_dwordx4 v[216:219], v2, s[24:27], s61 offen sc1
    buffer_store_dwordx4 v[220:223], v2, s[24:27], s61 offen offset:1024 sc1
    buffer_load_dwordx4 a[24:27], v2, s[24:27], s57 offen offset:2048
    buffer_load_dwordx4 a[28:31], v2, s[24:27], s57 offen offset:3072
    s_add_u32 s57, s57, 4096
    buffer_load_dwordx4 a[32:35], v2, s[24:27], s57 offen offset:0
    buffer_load_dwordx4 a[36:39], v2, s[24:27], s57 offen offset:1024
    s_waitcnt vmcnt(4)
    s_barrier
    s_lshl_b32 s55, s58, 8
    s_add_u32 s55, s55, 0xce8000
    s_cmp_lg_u32 s3, 0
    s_cbranch_scc1 KB_sgx2
    v_mov_b32 v7, 1
    s_mov_b64 exec, 1
    buffer_atomic_add v7, v9, s[24:27], s55 offen sc1
    s_mov_b64 exec, -1
KB_sgx2:
    s_cmp_lg_u32 s3, 0
    s_cbranch_scc1 KB_idleX2
    s_mov_b32 s45, 0
    s_mov_b64 exec, 1
KB_spinX2:
    buffer_load_dword v7, v9, s[24:27], s55 offen offset:0 sc1
    s_waitcnt vmcnt(0)
    v_readfirstlane_b32 s44, v7
    s_nop 0
    s_cmp_ge_u32 s44, 16
    s_cbranch_scc1 KB_okkX2
    s_sleep 4
    s_add_u32 s45, s45, 1
    s_cmp_lt_u32 s45, 100000
    s_cbranch_scc1 KB_spinX2
KB_okkX2:
    s_mov_b64 exec, -1
    s_branch KB_okX2
KB_idleX2:
    buffer_load_dwordx4 a[40:43], v2, s[24:27], s57 offen offset:2048
    buffer_load_dwordx4 a[44:47], v2, s[24:27], s57 offen offset:3072
    s_add_u32 s57, s57, 4096
    buffer_load_dwordx4 a[48:51], v2, s[24:27], s57 offen offset:0
    buffer_load_dwordx4 a[52:55], v2, s[24:27], s57 offen offset:1024
    buffer_load_dwordx4 a[56:59], v2, s[24:27], s57 offen offset:2048
    buffer_load_dwordx4 a[60:63], v2, s[24:27], s57 offen offset:3072
    s_add_u32 s57, s57, 4096
    buffer_load_dwordx4 a[64:67], v2, s[24:27], s57 offen offset:0
    buffer_load_dwordx4 a[68:71], v2, s[24:27], s57 offen offset:1024
    buffer_load_dwordx4 a[72:75], v2, s[24:27], s57 offen offset:2048
    buffer_load_dwordx4 a[76:79], v2, s[24:27], s57 offen offset:3072
    s_add_u32 s57, s57, 4096
    buffer_load_dwordx4 a[80:83], v2, s[24:27], s57 offen offset:0
    buffer_load_dwordx4 a[84:87], v2, s[24:27], s57 offen offset:1024
    buffer_load_dwordx4 a[88:91], v2, s[24:27], s57 offen offset:2048
    buffer_load_dwordx4 a[92:95], v2, s[24:27], s57 offen offset:3072
    s_add_u32 s57, s57, 4096
    buffer_load_dwordx4 a[96:99], v2, s[24:27], s57 offen offset:0
    buffer_load_dwordx4 a[100:103], v2, s[24:27], s57 offen offset:1024
    buffer_load_dwordx4 a[104:107], v2, s[24:27], s57 offen offset:2048
    buffer_load_dwordx4 a[108:111], v2, s[24:27], s57 offen offset:3072
    s_add_u32 s57, s57, 4096
    buffer_load_dwordx4 a[112:115], v2, s[24:27], s57 offen offset:0
    buffer_load_dwordx4 a[116:119], v2, s[24:27], s57 offen offset:1024
    buffer_load_dwordx4 a[120:123], v2, s[24:27], s57 offen offset:2048
    buffer_load_dwordx4 a[124:127], v2, s[24:27], s57 offen offset:3072
KB_okX2:
    s_barrier
    s_lshl_b32 s32, s52, 15
    s_lshl_b32 s33, s3, 13
    s_add_u32 s32, s32, s33
    s_add_u32 s32, s32, 0x1200000
    s_add_u32 m0, s33, 118784
    s_nop 0
    buffer_load_dwordx4 v2, s[24:27], s32 offen offset:0 lds
    buffer_load_dwordx4 v2, s[24:27], s32 offen offset:1024 lds
    buffer_load_dwordx4 v2, s[24:27], s32 offen offset:2048 lds
    buffer_load_dwordx4 v2, s[24:27], s32 offen offset:3072 lds
    s_add_u32 m0, s33, 122880
    s_add_u32 s32, s32, 4096
    buffer_load_dwordx4 v2, s[24:27], s32 offen offset:0 lds
    buffer_load_dwordx4 v2, s[24:27], s32 offen offset:1024 lds
    buffer_load_dwordx4 v2, s[24:27], s32 offen offset:2048 lds
    buffer_load_dwordx4 v2, s[24:27], s32 offen offset:3072 lds
    s_cmp_lg_u32 s3, 0
    s_cbranch_scc1 KB_w123
    buffer_load_dwordx4 a[40:43], v2, s[24:27], s57 offen offset:2048
    buffer_load_dwordx4 a[44:47], v2, s[24:27], s57 offen offset:3072
    s_add_u32 s57, s57, 4096
    buffer_load_dwordx4 a[48:51], v2, s[24:27], s57 offen offset:0
    buffer_load_dwordx4 a[52:55], v2, s[24:27], s57 offen offset:1024
    buffer_load_dwordx4 a[56:59], v2, s[24:27], s57 offen offset:2048
    buffer_load_dwordx4 a[60:63], v2, s[24:27], s57 offen offset:3072
    s_add_u32 s57, s57, 4096
    buffer_load_dwordx4 a[64:67], v2, s[24:27], s57 offen offset:0
    buffer_load_dwordx4 a[68:71], v2, s[24:27], s57 offen offset:1024
    buffer_load_dwordx4 a[72:75], v2, s[24:27], s57 offen offset:2048
    buffer_load_dwordx4 a[76:79], v2, s[24:27], s57 offen offset:3072
    s_add_u32 s57, s57, 4096
    buffer_load_dwordx4 a[80:83], v2, s[24:27], s57 offen offset:0
    buffer_load_dwordx4 a[84:87], v2, s[24:27], s57 offen offset:1024
    buffer_load_dwordx4 a[88:91], v2, s[24:27], s57 offen offset:2048
    buffer_load_dwordx4 a[92:95], v2, s[24:27], s57 offen offset:3072
    s_add_u32 s57, s57, 4096
    buffer_load_dwordx4 a[96:99], v2, s[24:27], s57 offen offset:0
    buffer_load_dwordx4 a[100:103], v2, s[24:27], s57 offen offset:1024
    buffer_load_dwordx4 a[104:107], v2, s[24:27], s57 offen offset:2048
    buffer_load_dwordx4 a[108:111], v2, s[24:27], s57 offen offset:3072
    s_add_u32 s57, s57, 4096
    buffer_load_dwordx4 a[112:115], v2, s[24:27], s57 offen offset:0
    buffer_load_dwordx4 a[116:119], v2, s[24:27], s57 offen offset:1024
    buffer_load_dwordx4 a[120:123], v2, s[24:27], s57 offen offset:2048
    buffer_load_dwordx4 a[124:127], v2, s[24:27], s57 offen offset:3072
    s_waitcnt vmcnt(22)
    s_branch KB_wj
KB_w123:
    s_waitcnt vmcnt(0)
KB_wj:
    s_barrier
    buffer_load_dwordx4 v[208:211], v12, s[48:51], 0 offen
    buffer_load_dwordx3 v[212:214], v12, s[48:51], 0 offen offset:16
    ds_read_b128 v[16:19], v14 offset:0
    ds_read_b128 v[20:23], v14 offset:1024
    ds_read_b128 v[24:27], v14 offset:2048
    ds_read_b128 v[28:31], v14 offset:3072
    ds_read_b128 v[32:35], v14 offset:4096
    ds_read_b128 v[36:39], v14 offset:5120
    ds_read_b128 v[40:43], v14 offset:6144
    ds_read_b128 v[44:47], v14 offset:7168
    ds_read_b128 v[48:51], v14 offset:8192
    ds_read_b128 v[52:55], v14 offset:9216
    ds_read_b128 v[56:59], v14 offset:10240
    ds_read_b128 v[60:63], v14 offset:11264
    ds_read_b128 v[64:67], v14 offset:12288
    ds_read_b128 v[68:71], v14 offset:13312
    ds_read_b128 v[72:75], v14 offset:14336
    ds_read_b128 v[76:79], v14 offset:15360
    ds_read_b128 v[80:83], v14 offset:16384
    ds_read_b128 v[84:87], v14 offset:17408
    ds_read_b128 v[88:91], v14 offset:18432
    ds_read_b128 v[92:95], v14 offset:19456
    ds_read_b128 v[96:99], v14 offset:20480
    ds_read_b128 v[100:103], v14 offset:21504
    ds_read_b128 v[104:107], v14 offset:22528
    ds_read_b128 v[108:111], v14 offset:23552
    ds_read_b128 v[112:115], v14 offset:24576
    ds_read_b128 v[116:119], v14 offset:25600
    ds_read_b128 v[120:123], v14 offset:26624
    ds_read_b128 v[124:127], v14 offset:27648
    ds_read_b128 v[128:131], v14 offset:28672
    ds_read_b128 v[132:135], v14 offset:29696
    ds_read_b128 v[136:139], v14 offset:30720
    ds_read_b128 v[140:143], v14 offset:31744
    s_waitcnt lgkmcnt(15)
    v_mfma_f32_32x32x16_bf16 v[144:159], a[0:3], v[16:19], 0
    s_add_u32 s18, s11, 0
    s_add_u32 m0, s8, 0
    s_nop 0
    buffer_load_dwordx4 v2, s[24:27], s18 offen offset:0 lds
    s_waitcnt lgkmcnt(15)
    v_mfma_f32_32x32x16_bf16 v[144:159], a[4:7], v[20:23], v[144:159]
    buffer_load_dwordx4 v2, s[24:27], s18 offen offset:1024 lds
    s_waitcnt lgkmcnt(15)
    v_mfma_f32_32x32x16_bf16 v[144:159], a[8:11], v[24:27], v[144:159]
    buffer_load_dwordx4 v2, s[24:27], s18 offen offset:2048 lds
    s_waitcnt lgkmcnt(15)
    v_mfma_f32_32x32x16_bf16 v[144:159], a[12:15], v[28:31], v[144:159]
    s_add_u32 s18, s11, 12288
    s_add_u32 m0, s8, 12288
    s_nop 0
    buffer_load_dwordx4 v2, s[24:27], s18 offen offset:0 lds
    s_waitcnt lgkmcnt(15)
    v_mfma_f32_32x32x16_bf16 v[144:159], a[16:19], v[32:35], v[144:159]
    buffer_load_dwordx4 v2, s[24:27], s18 offen offset:1024 lds
    s_waitcnt lgkmcnt(15)
    v_mfma_f32_32x32x16_bf16 v[144:159], a[20:23], v[36:39], v[144:159]
    buffer_load_dwordx4 v2, s[24:27], s18 offen offset:2048 lds
    s_waitcnt lgkmcnt(15)
    v_mfma_f32_32x32x16_bf16 v[144:159], a[24:27], v[40:43], v[144:159]
    s_add_u32 s18, s11, 24576
    s_add_u32 m0, s8, 24576
    s_nop 0
    buffer_load_dwordx4 v2, s[24:27], s18 offen offset:0 lds
    s_waitcnt lgkmcnt(15)
    v_mfma_f32_32x32x16_bf16 v[144:159], a[28:31], v[44:47], v[144:159]
    buffer_load_dwordx4 v2, s[24:27], s18 offen offset:1024 lds
    s_waitcnt lgkmcnt(15)
    v_mfma_f32_32x32x16_bf16 v[144:159], a[32:35], v[48:51], v[144:159]
    buffer_load_dwordx4 v2, s[24:27], s18 offen offset:2048 lds
    s_waitcnt lgkmcnt(15)
    v_mfma_f32_32x32x16_bf16 v[144:159], a[36:39], v[52:55], v[144:159]
    s_add_u32 s18, s11, 36864
    s_add_u32 m0, s8, 36864
    s_nop 0
    buffer_load_dwordx4 v2, s[24:27], s18 offen offset:0 lds
    s_waitcnt vmcnt(33) lgkmcnt(15)
    v_mfma_f32_32x32x16_bf16 v[144:159], a[40:43], v[56:59], v[144:159]
    buffer_load_dwordx4 v2, s[24:27], s18 offen offset:1024 lds
    s_waitcnt vmcnt(33) lgkmcnt(15)
    v_mfma_f32_32x32x16_bf16 v[144:159], a[44:47], v[60:63], v[144:159]
    buffer_load_dwordx4 v2, s[24:27], s18 offen offset:2048 lds
    s_waitcnt vmcnt(33) lgkmcnt(15)
    v_mfma_f32_32x32x16_bf16 v[144:159], a[48:51], v[64:67], v[144:159]
    s_waitcnt vmcnt(32) lgkmcnt(15)
    v_mfma_f32_32x32x16_bf16 v[144:159], a[52:55], v[68:71], v[144:159]
    s_waitcnt vmcnt(31) lgkmcnt(15)
    v_mfma_f32_32x32x16_bf16 v[144:159], a[56:59], v[72:75], v[144:159]
    s_waitcnt vmcnt(30) lgkmcnt(15)
    v_mfma_f32_32x32x16_bf16 v[144:159], a[60:63], v[76:79], v[144:159]
    s_waitcnt vmcnt(29) lgkmcnt(15)
    v_mfma_f32_32x32x16_bf16 v[144:159], a[64:67], v[80:83], v[144:159]
    s_waitcnt vmcnt(28) lgkmcnt(14)
    v_mfma_f32_32x32x16_bf16 v[144:159], a[68:71], v[84:87], v[144:159]
    s_waitcnt vmcnt(27) lgkmcnt(13)
    v_mfma_f32_32x32x16_bf16 v[144:159], a[72:75], v[88:91], v[144:159]
    s_waitcnt vmcnt(26) lgkmcnt(12)
    v_mfma_f32_32x32x16_bf16 v[144:159], a[76:79], v[92:95], v[144:159]
    s_waitcnt vmcnt(25) lgkmcnt(11)
    v_mfma_f32_32x32x16_bf16 v[144:159], a[80:83], v[96:99], v[144:159]
    s_waitcnt vmcnt(24) lgkmcnt(10)
    v_mfma_f32_32x32x16_bf16 v[144:159], a[84:87], v[100:103], v[144:159]
    s_waitcnt vmcnt(23) lgkmcnt(9)
    v_mfma_f32_32x32x16_bf16 v[144:159], a[88:91], v[104:107], v[144:159]
    s_waitcnt vmcnt(22) lgkmcnt(8)
    v_mfma_f32_32x32x16_bf16 v[144:159], a[92:95], v[108:111], v[144:159]
    s_waitcnt vmcnt(21) lgkmcnt(7)
    v_mfma_f32_32x32x16_bf16 v[144:159], a[96:99], v[112:115], v[144:159]
    s_waitcnt vmcnt(20) lgkmcnt(6)
    v_mfma_f32_32x32x16_bf16 v[144:159], a[100:103], v[116:119], v[144:159]
    s_waitcnt vmcnt(19) lgkmcnt(5)
    v_mfma_f32_32x32x16_bf16 v[144:159], a[104:107], v[120:123], v[144:159]
    s_waitcnt vmcnt(18) lgkmcnt(4)
    v_mfma_f32_32x32x16_bf16 v[144:159], a[108:111], v[124:127], v[144:159]
    s_waitcnt vmcnt(17) lgkmcnt(3)
    v_mfma_f32_32x32x16_bf16 v[144:159], a[112:115], v[128:131], v[144:159]
    s_waitcnt vmcnt(16) lgkmcnt(2)
    v_mfma_f32_32x32x16_bf16 v[144:159], a[116:119], v[132:135], v[144:159]
    s_waitcnt vmcnt(15) lgkmcnt(1)
    v_mfma_f32_32x32x16_bf16 v[144:159], a[120:123], v[136:139], v[144:159]
    s_waitcnt vmcnt(14) lgkmcnt(0)
    v_mfma_f32_32x32x16_bf16 v[144:159], a[124:127], v[140:143], v[144:159]
    s_waitcnt vmcnt(12)
    v_lshlrev_b32 v6, 16, v208
    v_and_b32 v7, 0xffff0000, v208
    s_nop 8
    v_add_f32 v6, v6, v144
    v_add_f32 v7, v7, v145
    v_cvt_pk_bf16_f32 v216, v6, v7
    v_add_f32 v160, v6, v7
    v_mul_f32 v161, v6, v6
    v_fmac_f32 v161, v7, v7
    v_lshlrev_b32 v6, 16, v209
    v_and_b32 v7, 0xffff0000, v209
    v_add_f32 v6, v6, v146
    v_add_f32 v7, v7, v147
    v_cvt_pk_bf16_f32 v217, v6, v7
    v_add_f32 v160, v160, v6
    v_fmac_f32 v161, v6, v6
    v_add_f32 v160, v160, v7
    v_fmac_f32 v161, v7, v7
    v_lshlrev_b32 v6, 16, v210
    v_and_b32 v7, 0xffff0000, v210
    v_add_f32 v6, v6, v148
    v_add_f32 v7, v7, v149
    v_cvt_pk_bf16_f32 v218, v6, v7
    v_add_f32 v160, v160, v6
    v_fmac_f32 v161, v6, v6
    v_add_f32 v160, v160, v7
    v_fmac_f32 v161, v7, v7
    v_lshlrev_b32 v6, 16, v211
    v_and_b32 v7, 0xffff0000, v211
    v_add_f32 v6, v6, v150
    v_add_f32 v7, v7, v151
    v_cvt_pk_bf16_f32 v219, v6, v7
    v_add_f32 v160, v160, v6
    v_fmac_f32 v161, v6, v6
    v_add_f32 v160, v160, v7
    v_fmac_f32 v161, v7, v7
    v_lshlrev_b32 v6, 16, v212
    v_and_b32 v7, 0xffff0000, v212
    v_add_f32 v6, v6, v152
    v_add_f32 v7, v7, v153
    v_cvt_pk_bf16_f32 v220, v6, v7
    v_add_f32 v160, v160, v6
    v_fmac_f32 v161, v6, v6
    v_add_f32 v160, v160, v7
    v_fmac_f32 v161, v7, v7
    v_lshlrev_b32 v6, 16, v213
    v_and_b32 v7, 0xffff0000, v213
    v_add_f32 v6, v6, v154
    v_add_f32 v7, v7, v155
    v_cvt_pk_bf16_f32 v221, v6, v7
    v_add_f32 v160, v160, v6
    v_fmac_f32 v161, v6, v6
    v_add_f32 v160, v160, v7
    v_fmac_f32 v161, v7, v7
    v_lshlrev_b32 v6, 16, v214
    v_and_b32 v7, 0xffff0000, v214
    v_add_f32 v6, v6, v156
    v_add_f32 v7, v7, v157
    v_cvt_pk_bf16_f32 v222, v6, v7
    v_add_f32 v160, v160, v6
    v_fmac_f32 v161, v6, v6
    v_add_f32 v160, v160, v7
    v_fmac_f32 v161, v7, v7
    s_mul_i32 s34, s3, 14
    s_add_u32 s35, s34, 0
    s_lshr_b32 s36, s35, 3
    s_lshl_b32 s36, s36, 10
    s_and_b32 s35, s35, 7
    s_lshl_b32 s35, s35, 1
    s_add_u32 s36, s36, s35
    s_add_u32 s36, s36, 155648
    v_add_u32 v164, s36, v2
    ds_write_b32 v164, v216
    s_add_u32 s35, s34, 2
    s_lshr_b32 s36, s35, 3
    s_lshl_b32 s36, s36, 10
    s_and_b32 s35, s35, 7
    s_lshl_b32 s35, s35, 1
    s_add_u32 s36, s36, s35
    s_add_u32 s36, s36, 155648
    v_add_u32 v165, s36, v2
    ds_write_b32 v165, v217
    s_add_u32 s35, s34, 4
    s_lshr_b32 s36, s35, 3
    s_lshl_b32 s36, s36, 10
    s_and_b32 s35, s35, 7
    s_lshl_b32 s35, s35, 1
    s_add_u32 s36, s36, s35
    s_add_u32 s36, s36, 155648
    v_add_u32 v166, s36, v2
    ds_write_b32 v166, v218
    s_add_u32 s35, s34, 6
    s_lshr_b32 s36, s35, 3
    s_lshl_b32 s36, s36, 10
    s_and_b32 s35, s35, 7
    s_lshl_b32 s35, s35, 1
    s_add_u32 s36, s36, s35
    s_add_u32 s36, s36, 155648
    v_add_u32 v167, s36, v2
    ds_write_b32 v167, v219
    s_add_u32 s35, s34, 8
    s_lshr_b32 s36, s35, 3
    s_lshl_b32 s36, s36, 10
    s_and_b32 s35, s35, 7
    s_lshl_b32 s35, s35, 1
    s_add_u32 s36, s36, s35
    s_add_u32 s36, s36, 155648
    v_add_u32 v168, s36, v2
    ds_write_b32 v168, v220
    s_add_u32 s35, s34, 10
    s_lshr_b32 s36, s35, 3
    s_lshl_b32 s36, s36, 10
    s_and_b32 s35, s35, 7
    s_lshl_b32 s35, s35, 1
    s_add_u32 s36, s36, s35
    s_add_u32 s36, s36, 155648
    v_add_u32 v169, s36, v2
    ds_write_b32 v169, v221
    s_add_u32 s35, s34, 12
    s_lshr_b32 s36, s35, 3
    s_lshl_b32 s36, s36, 10
    s_and_b32 s35, s35, 7
    s_lshl_b32 s35, s35, 1
    s_add_u32 s36, s36, s35
    s_add_u32 s36, s36, 155648
    v_add_u32 v170, s36, v2
    ds_write_b32 v170, v222
    v_mov_b32 v162, v160
    v_mov_b32 v163, v161
    s_nop 0
    v_permlane32_swap_b32 v160, v162
    v_permlane32_swap_b32 v161, v163
    v_add_f32 v160, v160, v162
    v_add_f32 v161, v161, v163
    v_and_b32 v6, 31, v1
    v_lshlrev_b32 v6, 3, v6
    s_lshl_b32 s32, s3, 8
    s_add_u32 s32, s32, 162816
    v_add_u32 v7, s32, v6
    ds_write_b64 v7, v[160:161]
    s_lshl_b32 s32, s3, 10
    s_add_u32 s32, s32, 155648
    v_add_u32 v7, s32, v2
    s_mul_i32 s33, s52, 28
    s_mul_i32 s34, s53, 7
    s_add_u32 s33, s33, s34
    s_add_u32 s33, s33, s3
    s_lshl_b32 s33, s33, 10
    s_add_u32 s33, s33, 0x1000000
    s_waitcnt lgkmcnt(0)
    s_barrier
    ds_read_b128 v[144:147], v7
    s_cmp_eq_u32 s3, 3
    s_cbranch_scc1 KB_w3st
    ds_read_b128 v[148:151], v7 offset:4096
    s_add_u32 s34, s33, 4096
    s_waitcnt lgkmcnt(0)
    buffer_store_dwordx4 v[148:151], v2, s[24:27], s34 offen sc1
    s_branch KB_stj
KB_w3st:
    v_add_u32 v7, 162816, v6
    ds_read_b64 v[148:149], v7 offset:0
    ds_read_b64 v[150:151], v7 offset:256
    ds_read_b64 v[152:153], v7 offset:512
    ds_read_b64 v[154:155], v7 offset:768
    s_lshl_b32 s34, s52, 2
    s_add_u32 s34, s34, s53
    s_lshl_b32 s34, s34, 8
    s_add_u32 s34, s34, 0xc80000
    s_waitcnt lgkmcnt(0)
    v_add_f32 v148, v148, v150
    v_add_f32 v149, v149, v151
    v_add_f32 v148, v148, v152
    v_add_f32 v149, v149, v153
    v_add_f32 v148, v148, v154
    v_add_f32 v149, v149, v155
    buffer_store_dwordx2 v[148:149], v6, s[24:27], s34 offen sc1
KB_stj:
    buffer_store_dwordx4 v[144:147], v2, s[24:27], s33 offen sc1
    s_add_u32 s18, s11, 49152
    s_add_u32 m0, s8, 49152
    s_nop 0
    buffer_load_dwordx4 v2, s[24:27], s18 offen offset:0 lds
    buffer_load_dwordx4 v2, s[24:27], s18 offen offset:1024 lds
    buffer_load_dwordx4 v2, s[24:27], s18 offen offset:2048 lds
    s_add_u32 s18, s11, 61440
    s_add_u32 m0, s8, 61440
    s_nop 0
    buffer_load_dwordx4 v2, s[24:27], s18 offen offset:0 lds
    buffer_load_dwordx4 v2, s[24:27], s18 offen offset:1024 lds
    buffer_load_dwordx4 v2, s[24:27], s18 offen offset:2048 lds
    s_add_u32 s18, s11, 73728
    s_add_u32 m0, s8, 73728
    s_nop 0
    buffer_load_dwordx4 v2, s[24:27], s18 offen offset:0 lds
    buffer_load_dwordx4 v2, s[24:27], s18 offen offset:1024 lds
    s_waitcnt vmcnt(8)
    s_barrier
    s_cmp_lg_u32 s3, 0
    s_cbranch_scc1 KB_sig3
    s_lshr_b32 s32, s52, 2
    s_lshl_b32 s32, s32, 10
    s_add_u32 s32, s32, 0xce4000
    v_lshlrev_b32 v6, 8, v1
    v_mov_b32 v7, 1
    s_mov_b64 exec, 0xf
    buffer_atomic_add v7, v6, s[24:27], s32 offen sc1
    s_mov_b64 exec, -1
KB_sig3:
    buffer_load_dwordx4 v2, s[24:27], s18 offen offset:2048 lds
    s_add_u32 s18, s12, 86016
    s_add_u32 m0, s10, 86016
    s_nop 0
    buffer_load_dwordx4 v2, s[24:27], s18 offen offset:0 lds
    buffer_load_dwordx4 v2, s[24:27], s18 offen offset:1024 lds
    buffer_load_dwordx4 v2, s[24:27], s18 offen offset:2048 lds
    buffer_load_dwordx4 v2, s[24:27], s18 offen offset:3072 lds
    s_add_u32 s18, s12, 102400
    s_add_u32 m0, s10, 102400
    s_nop 0
    buffer_load_dwordx4 v2, s[24:27], s18 offen offset:0 lds
    buffer_load_dwordx4 v2, s[24:27], s18 offen offset:1024 lds
    buffer_load_dwordx4 v2, s[24:27], s18 offen offset:2048 lds
    buffer_load_dwordx4 v2, s[24:27], s18 offen offset:3072 lds
    s_mul_i32 s32, s5, 896
    s_add_u32 s32, s32, 0xc00000
    s_mul_i32 s33, s3, 14336
    s_add_u32 s32, s32, s33
    s_lshl_b32 s33, s3, 10
    s_add_u32 m0, s33, 151552
    s_nop 0
    buffer_load_dwordx4 v2, s[24:27], s32 offen lds
    s_add_u32 s43, s41, 0
    buffer_load_dwordx4 a[144:147], v2, s[24:27], s43 offen offset:0
    s_add_u32 s43, s41, 114688
    buffer_load_dwordx4 a[148:151], v2, s[24:27], s43 offen offset:0
    s_add_u32 s43, s41, 4096
    buffer_load_dwordx4 a[152:155], v2, s[24:27], s43 offen offset:3072
    s_add_u32 s43, s41, 118784
    buffer_load_dwordx4 a[156:159], v2, s[24:27], s43 offen offset:3072
    s_add_u32 s43, s41, 12288
    buffer_load_dwordx4 a[160:163], v2, s[24:27], s43 offen offset:2048
    s_add_u32 s43, s41, 126976
    buffer_load_dwordx4 a[164:167], v2, s[24:27], s43 offen offset:2048
    s_add_u32 s43, s41, 20480
    buffer_load_dwordx4 a[168:171], v2, s[24:27], s43 offen offset:1024
    s_add_u32 s43, s41, 135168
    buffer_load_dwordx4 a[172:175], v2, s[24:27], s43 offen offset:1024
    s_lshl_b32 s55, s4, 10
    s_lshr_b32 s32, s30, 1
    s_lshl_b32 s32, s32, 8
    s_add_u32 s55, s55, s32
    s_add_u32 s55, s55, 0xce4000
    s_cmp_lg_u32 s3, 0
    s_cbranch_scc1 KB_idleX3
    s_mov_b32 s45, 0
    s_mov_b64 exec, 1
KB_spinX3:
    buffer_load_dword v7, v9, s[24:27], s55 offen offset:0 sc1
    s_waitcnt vmcnt(0)
    v_readfirstlane_b32 s44, v7
    s_nop 0
    s_cmp_ge_u32 s44, 16
    s_cbranch_scc1 KB_okkX3
    s_sleep 4
    s_add_u32 s45, s45, 1
    s_cmp_lt_u32 s45, 100000
    s_cbranch_scc1 KB_spinX3
KB_okkX3:
    s_mov_b64 exec, -1
    s_branch KB_okX3
KB_idleX3:
KB_okX3:
    s_barrier
    buffer_load_dwordx4 a[32:35], v2, s[24:27], s13 offen offset:0
    buffer_load_dwordx4 a[36:39], v2, s[24:27], s13 offen offset:1024
    buffer_load_dwordx4 a[40:43], v2, s[24:27], s13 offen offset:2048
    buffer_load_dwordx4 a[44:47], v2, s[24:27], s13 offen offset:3072
    s_add_u32 s13, s13, 4096
    buffer_load_dwordx4 a[48:51], v2, s[24:27], s13 offen offset:0
    buffer_load_dwordx4 a[52:55], v2, s[24:27], s13 offen offset:1024
    buffer_load_dwordx4 a[56:59], v2, s[24:27], s13 offen offset:2048
    buffer_load_dwordx4 a[60:63], v2, s[24:27], s13 offen offset:3072
    s_add_u32 s13, s13, 4096
    buffer_load_dwordx4 a[64:67], v2, s[24:27], s13 offen offset:0
    buffer_load_dwordx4 a[68:71], v2, s[24:27], s13 offen offset:1024
    buffer_load_dwordx4 a[72:75], v2, s[24:27], s13 offen offset:2048
    buffer_load_dwordx4 a[76:79], v2, s[24:27], s13 offen offset:3072
    s_add_u32 s13, s13, 4096
    v_and_b32 v6, 31, v1
    v_lshlrev_b32 v6, 3, v6
    v_lshrrev_b32 v7, 5, v1
    v_lshl_add_u32 v6, v7, 9, v6
    s_lshl_b32 s32, s6, 10
    s_add_u32 s32, s32, 0xc80000
    buffer_load_dwordx2 v[244:245], v6, s[24:27], s32 offen offset:0
    buffer_load_dwordx2 v[246:247], v6, s[24:27], s32 offen offset:256
    s_waitcnt vmcnt(22)
    s_barrier
    ds_read_b128 a[0:3], v2 offset:0
    ds_read_b128 a[4:7], v2 offset:1024
    ds_read_b128 a[8:11], v2 offset:2048
    ds_read_b128 a[12:15], v2 offset:3072
    ds_read_b128 a[16:19], v2 offset:4096
    ds_read_b128 a[20:23], v2 offset:5120
    ds_read_b128 a[24:27], v2 offset:6144
    s_waitcnt vmcnt(13)
    s_waitcnt lgkmcnt(4)
    v_mfma_f32_32x32x16_bf16 v[124:139], a[0:3], a[32:35], 0
    buffer_load_dwordx4 a[80:83], v2, s[24:27], s13 offen offset:0
    ds_read_b128 a[28:31], v2 offset:7168
    v_mfma_f32_32x32x16_bf16 v[140:155], a[4:7], a[32:35], 0
    buffer_load_dwordx4 a[84:87], v2, s[24:27], s13 offen offset:1024
    ds_read_b128 a[0:3], v2 offset:8192
    v_mfma_f32_32x32x16_bf16 v[156:171], a[8:11], a[32:35], 0
    buffer_load_dwordx4 a[88:91], v2, s[24:27], s13 offen offset:2048
    ds_read_b128 a[4:7], v2 offset:9216
    s_waitcnt vmcnt(15)
    s_waitcnt lgkmcnt(4)
    v_mfma_f32_32x32x16_bf16 v[124:139], a[12:15], a[36:39], v[124:139]
    buffer_load_dwordx4 a[92:95], v2, s[24:27], s13 offen offset:3072
    s_add_u32 s13, s13, 4096
    ds_read_b128 a[8:11], v2 offset:10240
    v_mfma_f32_32x32x16_bf16 v[140:155], a[16:19], a[36:39], v[140:155]
    buffer_load_dwordx4 a[96:99], v2, s[24:27], s13 offen offset:0
    ds_read_b128 a[12:15], v2 offset:11264
    v_mfma_f32_32x32x16_bf16 v[156:171], a[20:23], a[36:39], v[156:171]
    buffer_load_dwordx4 a[100:103], v2, s[24:27], s13 offen offset:1024
    ds_read_b128 a[16:19], v2 offset:12288
    s_waitcnt vmcnt(17)
    s_waitcnt lgkmcnt(4)
    v_mfma_f32_32x32x16_bf16 v[124:139], a[24:27], a[40:43], v[124:139]
    buffer_load_dwordx4 a[104:107], v2, s[24:27], s13 offen offset:2048
    ds_read_b128 a[20:23], v2 offset:13312
    v_mfma_f32_32x32x16_bf16 v[140:155], a[28:31], a[40:43], v[140:155]
    buffer_load_dwordx4 a[108:111], v2, s[24:27], s13 offen offset:3072
    s_add_u32 s13, s13, 4096
    ds_read_b128 a[24:27], v2 offset:14336
    v_mfma_f32_32x32x16_bf16 v[156:171], a[0:3], a[40:43], v[156:171]
    buffer_load_dwordx4 a[112:115], v2, s[24:27], s13 offen offset:0
    ds_read_b128 a[28:31], v2 offset:15360
    s_waitcnt vmcnt(19)
    s_waitcnt lgkmcnt(4)
    v_mfma_f32_32x32x16_bf16 v[124:139], a[4:7], a[44:47], v[124:139]
    buffer_load_dwordx4 a[116:119], v2, s[24:27], s13 offen offset:1024
    ds_read_b128 a[0:3], v2 offset:16384
    v_mfma_f32_32x32x16_bf16 v[140:155], a[8:11], a[44:47], v[140:155]
    buffer_load_dwordx4 a[120:123], v2, s[24:27], s13 offen offset:2048
    ds_read_b128 a[4:7], v2 offset:17408
    v_mfma_f32_32x32x16_bf16 v[156:171], a[12:15], a[44:47], v[156:171]
    buffer_load_dwordx4 a[124:127], v2, s[24:27], s13 offen offset:3072
    s_add_u32 s13, s13, 4096
    ds_read_b128 a[8:11], v2 offset:18432
    s_waitcnt vmcnt(21)
    s_waitcnt lgkmcnt(4)
    v_mfma_f32_32x32x16_bf16 v[124:139], a[16:19], a[48:51], v[124:139]
    buffer_load_dwordx4 a[128:131], v2, s[24:27], s13 offen offset:0
    ds_read_b128 a[12:15], v2 offset:19456
    v_mfma_f32_32x32x16_bf16 v[140:155], a[20:23], a[48:51], v[140:155]
    buffer_load_dwordx4 a[132:135], v2, s[24:27], s13 offen offset:1024
    ds_read_b128 a[16:19], v2 offset:20480
    v_mfma_f32_32x32x16_bf16 v[156:171], a[24:27], a[48:51], v[156:171]
    buffer_load_dwordx4 a[136:139], v2, s[24:27], s13 offen offset:2048
    ds_read_b128 a[20:23], v2 offset:21504
    s_waitcnt vmcnt(23)
    s_waitcnt lgkmcnt(4)
    v_mfma_f32_32x32x16_bf16 v[124:139], a[28:31], a[52:55], v[124:139]
    buffer_load_dwordx4 a[140:143], v2, s[24:27], s13 offen offset:3072
    s_add_u32 s13, s13, 4096
    ds_read_b128 a[24:27], v2 offset:22528
    v_mfma_f32_32x32x16_bf16 v[140:155], a[0:3], a[52:55], v[140:155]
    s_add_u32 s18, s12, 118784
    s_add_u32 m0, s10, 118784
    s_nop 0
    buffer_load_dwordx4 v2, s[24:27], s18 offen offset:0 lds
    ds_read_b128 a[28:31], v2 offset:23552
    v_mfma_f32_32x32x16_bf16 v[156:171], a[4:7], a[52:55], v[156:171]
    buffer_load_dwordx4 v2, s[24:27], s18 offen offset:1024 lds
    ds_read_b128 a[0:3], v2 offset:24576
    s_waitcnt vmcnt(25)
    s_waitcnt lgkmcnt(4)
    v_mfma_f32_32x32x16_bf16 v[124:139], a[8:11], a[56:59], v[124:139]
    buffer_load_dwordx4 v2, s[24:27], s18 offen offset:2048 lds
    ds_read_b128 a[4:7], v2 offset:25600
    v_mfma_f32_32x32x16_bf16 v[140:155], a[12:15], a[56:59], v[140:155]
    buffer_load_dwordx4 v2, s[24:27], s18 offen offset:3072 lds
    ds_read_b128 a[8:11], v2 offset:26624
    v_mfma_f32_32x32x16_bf16 v[156:171], a[16:19], a[56:59], v[156:171]
    s_add_u32 s18, s12, 135168
    s_add_u32 m0, s10, 135168
    s_nop 0
    buffer_load_dwordx4 v2, s[24:27], s18 offen offset:0 lds
    ds_read_b128 a[12:15], v2 offset:27648
    s_waitcnt vmcnt(27)
    s_waitcnt lgkmcnt(4)
    v_mfma_f32_32x32x16_bf16 v[124:139], a[20:23], a[60:63], v[124:139]
    buffer_load_dwordx4 v2, s[24:27], s18 offen offset:1024 lds
    ds_read_b128 a[16:19], v2 offset:28672
    v_mfma_f32_32x32x16_bf16 v[140:155], a[24:27], a[60:63], v[140:155]
    buffer_load_dwordx4 v2, s[24:27], s18 offen offset:2048 lds
    ds_read_b128 a[20:23], v2 offset:29696
    v_mfma_f32_32x32x16_bf16 v[156:171], a[28:31], a[60:63], v[156:171]
    buffer_load_dwordx4 v2, s[24:27], s18 offen offset:3072 lds
    ds_read_b128 a[24:27], v2 offset:30720
    s_waitcnt vmcnt(29)
    s_waitcnt lgkmcnt(4)
    v_mfma_f32_32x32x16_bf16 v[124:139], a[0:3], a[64:67], v[124:139]
    s_add_u32 s43, s41, 0
    buffer_load_dwordx4 a[176:179], v2, s[24:27], s43 offen offset:1024
    ds_read_b32 v236, v3 offset:0
    ds_read_b32 v237, v3 offset:128
    ds_read_b128 a[28:31], v2 offset:31744
    v_mfma_f32_32x32x16_bf16 v[140:155], a[4:7], a[64:67], v[140:155]
    ds_read_b32 v238, v3 offset:256
    ds_read_b32 v239, v3 offset:384
    ds_read_b128 a[0:3], v2 offset:32768
    v_mfma_f32_32x32x16_bf16 v[156:171], a[8:11], a[64:67], v[156:171]
    ds_read_b32 v240, v3 offset:512
    ds_read_b32 v241, v3 offset:640
    ds_read_b128 a[4:7], v2 offset:33792
    s_waitcnt vmcnt(29)
    s_waitcnt lgkmcnt(10)
    v_mfma_f32_32x32x16_bf16 v[124:139], a[12:15], a[68:71], v[124:139]
    s_add_u32 s43, s41, 114688
    buffer_load_dwordx4 a[180:183], v2, s[24:27], s43 offen offset:1024
    ds_read_b32 v242, v3 offset:768
    ds_read_b32 v220, v3 offset:1024
    ds_read_b128 a[8:11], v2 offset:34816
    v_mfma_f32_32x32x16_bf16 v[140:155], a[16:19], a[68:71], v[140:155]
    ds_read_b32 v221, v3 offset:1152
    ds_read_b32 v222, v3 offset:1280
    ds_read_b128 a[12:15], v2 offset:35840
    v_mfma_f32_32x32x16_bf16 v[156:171], a[20:23], a[68:71], v[156:171]
    ds_read_b32 v223, v3 offset:1408
    ds_read_b32 v224, v3 offset:1536
    ds_read_b128 a[16:19], v2 offset:36864
    s_waitcnt vmcnt(29)
    s_waitcnt lgkmcnt(12)
    v_mfma_f32_32x32x16_bf16 v[124:139], a[24:27], a[72:75], v[124:139]
    s_add_u32 s43, s41, 8192
    buffer_load_dwordx4 a[184:187], v2, s[24:27], s43 offen offset:0
    ds_read_b32 v225, v3 offset:1664
    ds_read_b32 v226, v3 offset:1792
    ds_read_b128 a[20:23], v2 offset:37888
    v_mfma_f32_32x32x16_bf16 v[140:155], a[28:31], a[72:75], v[140:155]
    s_waitcnt lgkmcnt(1)
    v_add_f32 v236, v236, v220
    v_add_f32 v237, v237, v221
    ds_read_b128 a[24:27], v2 offset:38912
    v_mfma_f32_32x32x16_bf16 v[156:171], a[0:3], a[72:75], v[156:171]
    v_add_f32 v238, v238, v222
    v_add_f32 v239, v239, v223
    v_add_f32 v240, v240, v224
    ds_read_b128 a[28:31], v2 offset:39936
    s_waitcnt vmcnt(29)
    v_mfma_f32_32x32x16_bf16 v[124:139], a[4:7], a[76:79], v[124:139]
    s_add_u32 s43, s41, 122880
    buffer_load_dwordx4 a[188:191], v2, s[24:27], s43 offen offset:0
    v_add_f32 v241, v241, v225
    v_add_f32 v242, v242, v226
    ds_read_b32 v220, v3 offset:2048
    ds_read_b128 a[0:3], v2 offset:40960
    v_mfma_f32_32x32x16_bf16 v[140:155], a[8:11], a[76:79], v[140:155]
    ds_read_b32 v221, v3 offset:2176
    ds_read_b32 v222, v3 offset:2304
    ds_read_b128 a[4:7], v2 offset:41984
    v_mfma_f32_32x32x16_bf16 v[156:171], a[12:15], a[76:79], v[156:171]
    ds_read_b32 v223, v3 offset:2432
    ds_read_b32 v224, v3 offset:2560
    ds_read_b128 a[8:11], v2 offset:43008
    s_waitcnt vmcnt(27)
    s_waitcnt lgkmcnt(9)
    v_mfma_f32_32x32x16_bf16 v[124:139], a[16:19], a[80:83], v[124:139]
    s_add_u32 s43, s41, 12288
    buffer_load_dwordx4 a[192:195], v2, s[24:27], s43 offen offset:3072
    ds_read_b32 v225, v3 offset:2688
    ds_read_b32 v226, v3 offset:2816
    ds_read_b128 a[12:15], v2 offset:44032
    v_mfma_f32_32x32x16_bf16 v[140:155], a[20:23], a[80:83], v[140:155]
    s_waitcnt lgkmcnt(1)
    v_add_f32 v236, v236, v220
    v_add_f32 v237, v237, v221
    ds_read_b128 a[16:19], v2 offset:45056
    v_mfma_f32_32x32x16_bf16 v[156:171], a[24:27], a[80:83], v[156:171]
    v_add_f32 v238, v238, v222
    v_add_f32 v239, v239, v223
    v_add_f32 v240, v240, v224
    ds_read_b128 a[20:23], v2 offset:46080
    s_waitcnt vmcnt(27)
    v_mfma_f32_32x32x16_bf16 v[124:139], a[28:31], a[84:87], v[124:139]
    s_add_u32 s43, s41, 126976
    buffer_load_dwordx4 a[196:199], v2, s[24:27], s43 offen offset:3072
    v_add_f32 v241, v241, v225
    v_add_f32 v242, v242, v226
    ds_read_b32 v220, v3 offset:3072
    ds_read_b128 a[24:27], v2 offset:47104
    v_mfma_f32_32x32x16_bf16 v[140:155], a[0:3], a[84:87], v[140:155]
    ds_read_b32 v221, v3 offset:3200
    ds_read_b32 v222, v3 offset:3328
    ds_read_b128 a[28:31], v2 offset:48128
    v_mfma_f32_32x32x16_bf16 v[156:171], a[4:7], a[84:87], v[156:171]
    ds_read_b32 v223, v3 offset:3456
    ds_read_b32 v224, v3 offset:3584
    s_barrier
    ds_read_b128 a[0:3], v2 offset:49152
    s_waitcnt vmcnt(27)
    s_waitcnt lgkmcnt(9)
    v_mfma_f32_32x32x16_bf16 v[124:139], a[8:11], a[88:91], v[124:139]
    s_add_u32 s18, s12, 151552
    s_add_u32 m0, s10, 0
    s_nop 0
    buffer_load_dwordx4 v2, s[24:27], s18 offen offset:0 lds
    ds_read_b32 v225, v3 offset:3712
    ds_read_b32 v226, v3 offset:3840
    ds_read_b128 a[4:7], v2 offset:50176
    v_mfma_f32_32x32x16_bf16 v[140:155], a[12:15], a[88:91], v[140:155]
    buffer_load_dwordx4 v2, s[24:27], s18 offen offset:1024 lds
    s_waitcnt lgkmcnt(1)
    v_add_f32 v236, v236, v220
    v_add_f32 v237, v237, v221
    ds_read_b128 a[8:11], v2 offset:51200
    v_mfma_f32_32x32x16_bf16 v[156:171], a[16:19], a[88:91], v[156:171]
    buffer_load_dwordx4 v2, s[24:27], s18 offen offset:2048 lds
    v_add_f32 v238, v238, v222
    v_add_f32 v239, v239, v223
    v_add_f32 v240, v240, v224
    ds_read_b128 a[12:15], v2 offset:52224
    s_waitcnt vmcnt(29)
    v_mfma_f32_32x32x16_bf16 v[124:139], a[20:23], a[92:95], v[124:139]
    buffer_load_dwordx4 v2, s[24:27], s18 offen offset:3072 lds
    v_add_f32 v241, v241, v225
    v_add_f32 v242, v242, v226
    v_cvt_pk_bf16_f32 v221, v236, 0
    ds_read_b128 a[16:19], v2 offset:53248
    v_mfma_f32_32x32x16_bf16 v[140:155], a[24:27], a[92:95], v[140:155]
    v_lshlrev_b32 v6, 16, v221
    v_sub_f32 v6, v236, v6
    v_cvt_pk_bf16_f32 v220, v236, v6
    ds_read_b128 a[20:23], v2 offset:54272
    v_mfma_f32_32x32x16_bf16 v[156:171], a[28:31], a[92:95], v[156:171]
    v_cvt_pk_bf16_f32 v223, v237, 0
    v_lshlrev_b32 v6, 16, v223
    v_sub_f32 v6, v237, v6
    ds_read_b128 a[24:27], v2 offset:55296
    s_waitcnt vmcnt(29)
    s_waitcnt lgkmcnt(4)
    v_mfma_f32_32x32x16_bf16 v[124:139], a[0:3], a[96:99], v[124:139]
    s_add_u32 s43, s41, 20480
    buffer_load_dwordx4 a[200:203], v2, s[24:27], s43 offen offset:2048
    v_cvt_pk_bf16_f32 v222, v237, v6
    v_cvt_pk_bf16_f32 v225, v238, 0
    v_lshlrev_b32 v6, 16, v225
    ds_read_b128 a[28:31], v2 offset:56320
    v_mfma_f32_32x32x16_bf16 v[140:155], a[4:7], a[96:99], v[140:155]
    v_sub_f32 v6, v238, v6
    v_cvt_pk_bf16_f32 v224, v238, v6
    v_cvt_pk_bf16_f32 v227, v239, 0
    ds_read_b128 a[0:3], v2 offset:57344
    v_mfma_f32_32x32x16_bf16 v[156:171], a[8:11], a[96:99], v[156:171]
    v_lshlrev_b32 v6, 16, v227
    v_sub_f32 v6, v239, v6
    v_cvt_pk_bf16_f32 v226, v239, v6
    ds_read_b128 a[4:7], v2 offset:58368
    s_waitcnt vmcnt(29)
    s_waitcnt lgkmcnt(4)
    v_mfma_f32_32x32x16_bf16 v[124:139], a[12:15], a[100:103], v[124:139]
    s_add_u32 s43, s41, 135168
    buffer_load_dwordx4 a[204:207], v2, s[24:27], s43 offen offset:2048
    v_cvt_pk_bf16_f32 v229, v240, 0
    v_lshlrev_b32 v6, 16, v229
    v_sub_f32 v6, v240, v6
    ds_read_b128 a[8:11], v2 offset:59392
    v_mfma_f32_32x32x16_bf16 v[140:155], a[16:19], a[100:103], v[140:155]
    v_cvt_pk_bf16_f32 v228, v240, v6
    v_cvt_pk_bf16_f32 v231, v241, 0
    v_lshlrev_b32 v6, 16, v231
    ds_read_b128 a[12:15], v2 offset:60416
    v_mfma_f32_32x32x16_bf16 v[156:171], a[20:23], a[100:103], v[156:171]
    v_sub_f32 v6, v241, v6
    v_cvt_pk_bf16_f32 v230, v241, v6
    v_cvt_pk_bf16_f32 v233, v242, 0
    ds_read_b128 a[16:19], v4 offset:0
    s_waitcnt vmcnt(29)
    s_waitcnt lgkmcnt(4)
    v_mfma_f32_32x32x16_bf16 v[124:139], a[24:27], a[104:107], v[124:139]
    s_add_u32 s43, s41, 0
    buffer_load_dwordx4 a[208:211], v2, s[24:27], s43 offen offset:2048
    v_lshlrev_b32 v6, 16, v233
    v_sub_f32 v6, v242, v6
    v_cvt_pk_bf16_f32 v232, v242, v6
    ds_read_b128 a[20:23], v4 offset:1024
    v_mfma_f32_32x32x16_bf16 v[140:155], a[28:31], a[104:107], v[140:155]
    v_add_f32 v244, v244, v246
    v_add_f32 v245, v245, v247
    ds_read_b128 a[24:27], v4 offset:2048
    v_mfma_f32_32x32x16_bf16 v[156:171], a[0:3], a[104:107], v[156:171]
    v_mov_b32 v6, v244
    v_mov_b32 v7, v245
    s_nop 0
    v_permlane32_swap_b32 v244, v6
    ds_read_b128 a[28:31], v4 offset:3072
    s_waitcnt vmcnt(29)
    s_waitcnt lgkmcnt(4)
    v_mfma_f32_32x32x16_bf16 v[124:139], a[4:7], a[108:111], v[124:139]
    s_add_u32 s43, s41, 114688
    buffer_load_dwordx4 a[212:215], v2, s[24:27], s43 offen offset:2048
    v_permlane32_swap_b32 v245, v7
    v_add_f32 v10, v244, v6
    v_add_f32 v11, v245, v7
    ds_read_b128 a[0:3], v4 offset:4096
    v_mfma_f32_32x32x16_bf16 v[140:155], a[8:11], a[108:111], v[140:155]
    v_mul_f32 v10, 0xbb124925, v10
    v_mul_f32 v11, 0x3b124925, v11
    v_fma_f32 v11, -v10, v10, v11
    ds_read_b128 a[4:7], v4 offset:5120
    v_mfma_f32_32x32x16_bf16 v[156:171], a[12:15], a[108:111], v[156:171]
    v_max_f32 v11, 0, v11
    v_add_f32 v11, 0x3727c5ac, v11
    v_rsq_f32 v8, v11
    ds_read_b128 a[8:11], v4 offset:6144
    s_waitcnt vmcnt(29)
    s_waitcnt lgkmcnt(4)
    v_mfma_f32_32x32x16_bf16 v[124:139], a[16:19], a[112:115], v[124:139]
    s_add_u32 s43, s41, 8192
    buffer_load_dwordx4 a[216:219], v2, s[24:27], s43 offen offset:1024
    v_sqrt_f32 v11, v11
    v_mul_f32 v8, 0xbfb8aa3b, v8
    v_cvt_pk_bf16_f32 v248, v10, v10
    ds_read_b128 a[12:15], v4 offset:7168
    v_mfma_f32_32x32x16_bf16 v[140:155], a[20:23], a[112:115], v[140:155]
    v_lshlrev_b32 v6, 16, v248
    v_sub_f32 v6, v10, v6
    v_cvt_pk_bf16_f32 v249, v6, 0
    ds_read_b128 a[16:19], v4 offset:8192
    v_mfma_f32_32x32x16_bf16 v[156:171], a[24:27], a[112:115], v[156:171]
    v_cmp_gt_u32 vcc, 32, v1
    s_nop 1
    v_cndmask_b32 v248, 0, v248, vcc
    v_cndmask_b32 v249, 0, v249, vcc
    ds_read_b128 a[20:23], v4 offset:9216
    s_waitcnt vmcnt(29)
    s_waitcnt lgkmcnt(4)
    v_mfma_f32_32x32x16_bf16 v[124:139], a[28:31], a[116:119], v[124:139]
    s_add_u32 s43, s41, 122880
    buffer_load_dwordx4 a[220:223], v2, s[24:27], s43 offen offset:1024
    v_mov_b32 v250, 0
    v_mov_b32 v251, 0
    v_mov_b32 v234, 0
    ds_read_b128 a[24:27], v4 offset:10240
    v_mfma_f32_32x32x16_bf16 v[140:155], a[0:3], a[116:119], v[140:155]
    v_mov_b32 v235, 0
    ds_read_b128 a[28:31], v4 offset:11264
    v_mfma_f32_32x32x16_bf16 v[156:171], a[4:7], a[116:119], v[156:171]
    s_barrier
    ds_read_b128 a[0:3], v4 offset:12288
    s_waitcnt vmcnt(29)
    s_waitcnt lgkmcnt(4)
    v_mfma_f32_32x32x16_bf16 v[124:139], a[8:11], a[120:123], v[124:139]
    s_add_u32 s18, s12, 167936
    s_add_u32 m0, s10, 16384
    s_nop 0
    buffer_load_dwordx4 v2, s[24:27], s18 offen offset:0 lds
    ds_read_b128 a[4:7], v4 offset:13312
    v_mfma_f32_32x32x16_bf16 v[140:155], a[12:15], a[120:123], v[140:155]
    buffer_load_dwordx4 v2, s[24:27], s18 offen offset:1024 lds
    ds_read_b128 a[8:11], v4 offset:14336
    v_mfma_f32_32x32x16_bf16 v[156:171], a[16:19], a[120:123], v[156:171]
    buffer_load_dwordx4 v2, s[24:27], s18 offen offset:2048 lds
    ds_read_b128 a[12:15], v4 offset:15360
    s_waitcnt vmcnt(31)
    s_waitcnt lgkmcnt(4)
    v_mfma_f32_32x32x16_bf16 v[124:139], a[20:23], a[124:127], v[124:139]
    buffer_load_dwordx4 v2, s[24:27], s18 offen offset:3072 lds
    ds_read_b128 a[16:19], v4 offset:16384
    v_mfma_f32_32x32x16_bf16 v[140:155], a[24:27], a[124:127], v[140:155]
    ds_read_b128 a[20:23], v4 offset:17408
    v_mfma_f32_32x32x16_bf16 v[156:171], a[28:31], a[124:127], v[156:171]
    ds_read_b128 a[24:27], v4 offset:18432
    s_waitcnt vmcnt(31)
    s_waitcnt lgkmcnt(4)
    v_mfma_f32_32x32x16_bf16 v[124:139], a[0:3], a[128:131], v[124:139]
    s_add_u32 s43, s41, 16384
    buffer_load_dwordx4 a[224:227], v2, s[24:27], s43 offen offset:0
    ds_read_b128 a[28:31], v4 offset:19456
    v_mfma_f32_32x32x16_bf16 v[140:155], a[4:7], a[128:131], v[140:155]
    ds_read_b128 a[0:3], v4 offset:20480
    v_mfma_f32_32x32x16_bf16 v[156:171], a[8:11], a[128:131], v[156:171]
    ds_read_b128 a[4:7], v4 offset:21504
    s_waitcnt vmcnt(31)
    s_waitcnt lgkmcnt(4)
    v_mfma_f32_32x32x16_bf16 v[124:139], a[12:15], a[132:135], v[124:139]
    s_add_u32 s43, s41, 131072
    buffer_load_dwordx4 a[228:231], v2, s[24:27], s43 offen offset:0
    ds_read_b128 a[8:11], v4 offset:22528
    v_mfma_f32_32x32x16_bf16 v[140:155], a[16:19], a[132:135], v[140:155]
    ds_read_b128 a[12:15], v4 offset:23552
    v_mfma_f32_32x32x16_bf16 v[156:171], a[20:23], a[132:135], v[156:171]
    ds_read_b128 a[16:19], v4 offset:24576
    s_waitcnt vmcnt(31)
    s_waitcnt lgkmcnt(4)
    v_mfma_f32_32x32x16_bf16 v[124:139], a[24:27], a[136:139], v[124:139]
    s_add_u32 s43, s41, 20480
    buffer_load_dwordx4 a[232:235], v2, s[24:27], s43 offen offset:3072
    ds_read_b128 a[20:23], v4 offset:25600
    v_mfma_f32_32x32x16_bf16 v[140:155], a[28:31], a[136:139], v[140:155]
    ds_read_b128 a[24:27], v4 offset:26624
    v_mfma_f32_32x32x16_bf16 v[156:171], a[0:3], a[136:139], v[156:171]
    ds_read_b128 a[28:31], v4 offset:27648
    s_waitcnt vmcnt(31)
    s_waitcnt lgkmcnt(4)
    v_mfma_f32_32x32x16_bf16 v[124:139], a[4:7], a[140:143], v[124:139]
    v_mfma_f32_32x32x16_bf16 v[124:139], v[220:223], v[248:251], v[124:139]
    s_add_u32 s43, s41, 135168
    buffer_load_dwordx4 a[236:239], v2, s[24:27], s43 offen offset:3072
    ds_read_b128 a[0:3], v4 offset:28672
    v_mfma_f32_32x32x16_bf16 v[140:155], a[8:11], a[140:143], v[140:155]
    v_mfma_f32_32x32x16_bf16 v[140:155], v[222:225], v[248:251], v[140:155]
    ds_read_b128 a[4:7], v4 offset:29696
    v_mfma_f32_32x32x16_bf16 v[156:171], a[12:15], a[140:143], v[156:171]
    v_mfma_f32_32x32x16_bf16 v[156:171], v[224:227], v[248:251], v[156:171]
    ds_read_b128 a[8:11], v4 offset:30720
    s_waitcnt lgkmcnt(4)
    v_mfma_f32_32x32x16_bf16 v[172:187], a[16:19], a[32:35], 0
    s_add_u32 s43, s41, 0
    buffer_load_dwordx4 a[240:243], v2, s[24:27], s43 offen offset:3072
    ds_read_b128 a[12:15], v4 offset:31744
    v_mfma_f32_32x32x16_bf16 v[188:203], a[20:23], a[32:35], 0
    ds_read_b128 a[16:19], v4 offset:32768
    v_mfma_f32_32x32x16_bf16 v[172:187], a[24:27], a[36:39], v[172:187]
    v_mul_f32 v236, v8, v124
    v_mul_f32 v237, v8, v125
    v_mul_f32 v238, v8, v126
    ds_read_b128 a[20:23], v4 offset:33792
    s_waitcnt lgkmcnt(4)
    v_mfma_f32_32x32x16_bf16 v[188:203], a[28:31], a[36:39], v[188:203]
    s_add_u32 s43, s41, 114688
    buffer_load_dwordx4 a[244:247], v2, s[24:27], s43 offen offset:3072
    v_mul_f32 v239, v8, v127
    v_mul_f32 v240, v8, v128
    v_mul_f32 v241, v8, v129
    ds_read_b128 a[24:27], v4 offset:34816
    v_mfma_f32_32x32x16_bf16 v[172:187], a[0:3], a[40:43], v[172:187]
    v_mul_f32 v242, v8, v130
    v_mul_f32 v243, v8, v131
    v_exp_f32 v236, v236
    ds_read_b128 a[28:31], v4 offset:35840
    v_mfma_f32_32x32x16_bf16 v[188:203], a[4:7], a[40:43], v[188:203]
    v_exp_f32 v237, v237
    v_exp_f32 v238, v238
    ds_read_b128 a[0:3], v4 offset:36864
    s_waitcnt lgkmcnt(4)
    v_mfma_f32_32x32x16_bf16 v[172:187], a[8:11], a[44:47], v[172:187]
    s_add_u32 s43, s41, 8192
    buffer_load_dwordx4 a[248:251], v2, s[24:27], s43 offen offset:2048
    v_exp_f32 v239, v239
    v_exp_f32 v240, v240
    ds_read_b128 a[4:7], v4 offset:37888
    v_mfma_f32_32x32x16_bf16 v[188:203], a[12:15], a[44:47], v[188:203]
    v_exp_f32 v241, v241
    v_exp_f32 v242, v242
    ds_read_b128 a[8:11], v4 offset:38912
    v_mfma_f32_32x32x16_bf16 v[172:187], a[16:19], a[48:51], v[172:187]
    v_exp_f32 v243, v243
    v_fma_f32 v236, v236, v11, v11
    ds_read_b128 a[12:15], v4 offset:39936
    s_waitcnt lgkmcnt(4)
    v_mfma_f32_32x32x16_bf16 v[188:203], a[20:23], a[48:51], v[188:203]
    s_add_u32 s43, s41, 122880
    buffer_load_dwordx4 a[252:255], v2, s[24:27], s43 offen offset:2048
    v_fma_f32 v237, v237, v11, v11
    v_fma_f32 v238, v238, v11, v11
    v_fma_f32 v239, v239, v11, v11
    s_barrier
    ds_read_b128 a[16:19], v4 offset:40960
    v_mfma_f32_32x32x16_bf16 v[172:187], a[24:27], a[52:55], v[172:187]
    s_add_u32 s18, s12, 184320
    s_add_u32 m0, s10, 32768
    s_nop 0
    buffer_load_dwordx4 v2, s[24:27], s18 offen offset:0 lds
    v_fma_f32 v240, v240, v11, v11
    v_fma_f32 v241, v241, v11, v11
    v_fma_f32 v242, v242, v11, v11
    ds_read_b128 a[20:23], v4 offset:41984
    v_mfma_f32_32x32x16_bf16 v[188:203], a[28:31], a[52:55], v[188:203]
    buffer_load_dwordx4 v2, s[24:27], s18 offen offset:1024 lds
    v_fma_f32 v243, v243, v11, v11
    v_rcp_f32 v236, v236
    ds_read_b128 a[24:27], v4 offset:43008
    s_waitcnt lgkmcnt(4)
    v_mfma_f32_32x32x16_bf16 v[172:187], a[0:3], a[56:59], v[172:187]
    buffer_load_dwordx4 v2, s[24:27], s18 offen offset:2048 lds
    v_rcp_f32 v237, v237
    v_rcp_f32 v238, v238
    ds_read_b128 a[28:31], v4 offset:44032
    v_mfma_f32_32x32x16_bf16 v[188:203], a[4:7], a[56:59], v[188:203]
    buffer_load_dwordx4 v2, s[24:27], s18 offen offset:3072 lds
    v_rcp_f32 v239, v239
    v_rcp_f32 v240, v240
    ds_read_b128 a[0:3], v4 offset:45056
    v_mfma_f32_32x32x16_bf16 v[172:187], a[8:11], a[60:63], v[172:187]
    v_rcp_f32 v241, v241
    v_rcp_f32 v242, v242
    ds_read_b128 a[4:7], v4 offset:46080
    s_waitcnt lgkmcnt(4)
    v_mfma_f32_32x32x16_bf16 v[188:203], a[12:15], a[60:63], v[188:203]
    s_add_u32 s43, s41, 16384
    buffer_load_dwordx4 v[12:15], v2, s[24:27], s43 offen offset:1024
    v_rcp_f32 v243, v243
    v_mul_f32 v236, v236, v132
    ds_read_b128 a[8:11], v4 offset:47104
    v_mfma_f32_32x32x16_bf16 v[172:187], a[16:19], a[64:67], v[172:187]
    v_mul_f32 v237, v237, v133
    v_mul_f32 v238, v238, v134
    v_mul_f32 v239, v239, v135
    ds_read_b128 a[12:15], v4 offset:48128
    v_mfma_f32_32x32x16_bf16 v[188:203], a[20:23], a[64:67], v[188:203]
    v_mul_f32 v240, v240, v136
    v_mul_f32 v241, v241, v137
    v_mul_f32 v242, v242, v138
    ds_read_b128 a[16:19], v4 offset:49152
    s_waitcnt lgkmcnt(4)
    v_mfma_f32_32x32x16_bf16 v[172:187], a[24:27], a[68:71], v[172:187]
    s_add_u32 s43, s41, 131072
    buffer_load_dwordx4 v[16:19], v2, s[24:27], s43 offen offset:1024
    v_mul_f32 v243, v243, v139
    v_cvt_pk_bf16_f32 v244, v236, v237
    v_cvt_pk_bf16_f32 v245, v238, v239
    ds_read_b128 a[20:23], v4 offset:50176
    v_mfma_f32_32x32x16_bf16 v[188:203], a[28:31], a[68:71], v[188:203]
    v_cvt_pk_bf16_f32 v246, v240, v241
    v_cvt_pk_bf16_f32 v247, v242, v243
    buffer_store_dwordx4 v[244:247], v2, s[24:27], s9 offen offset:0 sc1
    ds_read_b128 a[24:27], v4 offset:51200
    v_mfma_f32_32x32x16_bf16 v[172:187], a[0:3], a[72:75], v[172:187]
    v_mul_f32 v236, v8, v140
    v_mul_f32 v237, v8, v141
    v_mul_f32 v238, v8, v142
    ds_read_b128 a[28:31], v4 offset:52224
    s_waitcnt lgkmcnt(4)
    v_mfma_f32_32x32x16_bf16 v[188:203], a[4:7], a[72:75], v[188:203]
    s_add_u32 s43, s41, 24576
    buffer_load_dwordx4 v[20:23], v2, s[24:27], s43 offen offset:0
    v_mul_f32 v239, v8, v143
    v_mul_f32 v240, v8, v144
    v_mul_f32 v241, v8, v145
    ds_read_b128 a[0:3], v4 offset:53248
    v_mfma_f32_32x32x16_bf16 v[172:187], a[8:11], a[76:79], v[172:187]
    v_mul_f32 v242, v8, v146
    v_mul_f32 v243, v8, v147
    v_exp_f32 v236, v236
    ds_read_b128 a[4:7], v4 offset:54272
    v_mfma_f32_32x32x16_bf16 v[188:203], a[12:15], a[76:79], v[188:203]
    v_exp_f32 v237, v237
    v_exp_f32 v238, v238
    ds_read_b128 a[8:11], v4 offset:55296
    s_waitcnt lgkmcnt(4)
    v_mfma_f32_32x32x16_bf16 v[172:187], a[16:19], a[80:83], v[172:187]
    s_add_u32 s43, s41, 139264
    buffer_load_dwordx4 v[24:27], v2, s[24:27], s43 offen offset:0
    v_exp_f32 v239, v239
    v_exp_f32 v240, v240
    ds_read_b128 a[12:15], v4 offset:56320
    v_mfma_f32_32x32x16_bf16 v[188:203], a[20:23], a[80:83], v[188:203]
    v_exp_f32 v241, v241
    v_exp_f32 v242, v242
    s_waitcnt vmcnt(41)
    s_barrier
    ds_read_b128 a[16:19], v4 offset:57344
    v_mfma_f32_32x32x16_bf16 v[172:187], a[24:27], a[84:87], v[172:187]
    v_exp_f32 v243, v243
    v_fma_f32 v236, v236, v11, v11
    ds_read_b128 a[20:23], v4 offset:58368
    s_waitcnt lgkmcnt(4)
    v_mfma_f32_32x32x16_bf16 v[188:203], a[28:31], a[84:87], v[188:203]
    s_add_u32 s43, s41, 4096
    buffer_load_dwordx4 v[28:31], v2, s[24:27], s43 offen offset:0
    v_fma_f32 v237, v237, v11, v11
    v_fma_f32 v238, v238, v11, v11
    v_fma_f32 v239, v239, v11, v11
    ds_read_b128 a[24:27], v4 offset:59392
    v_mfma_f32_32x32x16_bf16 v[172:187], a[0:3], a[88:91], v[172:187]
    v_fma_f32 v240, v240, v11, v11
    v_fma_f32 v241, v241, v11, v11
    v_fma_f32 v242, v242, v11, v11
    ds_read_b128 a[28:31], v4 offset:60416
    v_mfma_f32_32x32x16_bf16 v[188:203], a[4:7], a[88:91], v[188:203]
    v_fma_f32 v243, v243, v11, v11
    v_rcp_f32 v236, v236
    ds_read_b128 a[0:3], v5 offset:0
    s_waitcnt lgkmcnt(4)
    v_mfma_f32_32x32x16_bf16 v[172:187], a[8:11], a[92:95], v[172:187]
    s_add_u32 s43, s41, 118784
    buffer_load_dwordx4 v[32:35], v2, s[24:27], s43 offen offset:0
    v_rcp_f32 v237, v237
    v_rcp_f32 v238, v238
    ds_read_b128 a[4:7], v5 offset:1024
    v_mfma_f32_32x32x16_bf16 v[188:203], a[12:15], a[92:95], v[188:203]
    v_rcp_f32 v239, v239
    v_rcp_f32 v240, v240
    ds_read_b128 a[8:11], v5 offset:2048
    v_mfma_f32_32x32x16_bf16 v[172:187], a[16:19], a[96:99], v[172:187]
    v_rcp_f32 v241, v241
    v_rcp_f32 v242, v242
    ds_read_b128 a[12:15], v5 offset:3072
    s_waitcnt lgkmcnt(4)
    v_mfma_f32_32x32x16_bf16 v[188:203], a[20:23], a[96:99], v[188:203]
    s_add_u32 s43, s41, 8192
    buffer_load_dwordx4 v[36:39], v2, s[24:27], s43 offen offset:3072
    v_rcp_f32 v243, v243
    v_mul_f32 v236, v236, v148
    ds_read_b128 a[16:19], v5 offset:4096
    v_mfma_f32_32x32x16_bf16 v[172:187], a[24:27], a[100:103], v[172:187]
    v_mul_f32 v237, v237, v149
    v_mul_f32 v238, v238, v150
    v_mul_f32 v239, v239, v151
    ds_read_b128 a[20:23], v5 offset:5120
    v_mfma_f32_32x32x16_bf16 v[188:203], a[28:31], a[100:103], v[188:203]
    v_mul_f32 v240, v240, v152
    v_mul_f32 v241, v241, v153
    v_mul_f32 v242, v242, v154
    ds_read_b128 a[24:27], v5 offset:6144
    s_waitcnt lgkmcnt(4)
    v_mfma_f32_32x32x16_bf16 v[172:187], a[0:3], a[104:107], v[172:187]
    s_add_u32 s43, s41, 122880
    buffer_load_dwordx4 v[40:43], v2, s[24:27], s43 offen offset:3072
    v_mul_f32 v243, v243, v155
    v_cvt_pk_bf16_f32 v244, v236, v237
    v_cvt_pk_bf16_f32 v245, v238, v239
    ds_read_b128 a[28:31], v5 offset:7168
    v_mfma_f32_32x32x16_bf16 v[188:203], a[4:7], a[104:107], v[188:203]
    v_cvt_pk_bf16_f32 v246, v240, v241
    v_cvt_pk_bf16_f32 v247, v242, v243
    buffer_store_dwordx4 v[244:247], v2, s[24:27], s9 offen offset:1024 sc1
    ds_read_b128 a[0:3], v5 offset:8192
    v_mfma_f32_32x32x16_bf16 v[172:187], a[8:11], a[108:111], v[172:187]
    v_mul_f32 v236, v8, v156
    v_mul_f32 v237, v8, v157
    v_mul_f32 v238, v8, v158
    ds_read_b128 a[4:7], v5 offset:9216
    s_waitcnt lgkmcnt(4)
    v_mfma_f32_32x32x16_bf16 v[188:203], a[12:15], a[108:111], v[188:203]
    s_add_u32 s43, s41, 16384
    buffer_load_dwordx4 v[44:47], v2, s[24:27], s43 offen offset:2048
    v_mul_f32 v239, v8, v159
    v_mul_f32 v240, v8, v160
    v_mul_f32 v241, v8, v161
    ds_read_b128 a[8:11], v5 offset:10240
    v_mfma_f32_32x32x16_bf16 v[172:187], a[16:19], a[112:115], v[172:187]
    v_mul_f32 v242, v8, v162
    v_mul_f32 v243, v8, v163
    v_exp_f32 v236, v236
    ds_read_b128 a[12:15], v5 offset:11264
    v_mfma_f32_32x32x16_bf16 v[188:203], a[20:23], a[112:115], v[188:203]
    v_exp_f32 v237, v237
    v_exp_f32 v238, v238
    s_waitcnt vmcnt(43)
    s_barrier
    ds_read_b128 a[16:19], v5 offset:12288
    s_waitcnt lgkmcnt(4)
    v_mfma_f32_32x32x16_bf16 v[172:187], a[24:27], a[116:119], v[172:187]
    s_add_u32 s43, s41, 131072
    buffer_load_dwordx4 v[48:51], v2, s[24:27], s43 offen offset:2048
    v_exp_f32 v239, v239
    v_exp_f32 v240, v240
    ds_read_b128 a[20:23], v5 offset:13312
    v_mfma_f32_32x32x16_bf16 v[188:203], a[28:31], a[116:119], v[188:203]
    v_exp_f32 v241, v241
    v_exp_f32 v242, v242
    ds_read_b128 a[24:27], v5 offset:14336
    v_mfma_f32_32x32x16_bf16 v[172:187], a[0:3], a[120:123], v[172:187]
    v_exp_f32 v243, v243
    v_fma_f32 v236, v236, v11, v11
    ds_read_b128 a[28:31], v5 offset:15360
    s_waitcnt lgkmcnt(4)
    v_mfma_f32_32x32x16_bf16 v[188:203], a[4:7], a[120:123], v[188:203]
    s_add_u32 s43, s41, 24576
    buffer_load_dwordx4 v[52:55], v2, s[24:27], s43 offen offset:1024
    v_fma_f32 v237, v237, v11, v11
    v_fma_f32 v238, v238, v11, v11
    v_fma_f32 v239, v239, v11, v11
    ds_read_b128 a[0:3], v5 offset:16384
    v_mfma_f32_32x32x16_bf16 v[172:187], a[8:11], a[124:127], v[172:187]
    v_fma_f32 v240, v240, v11, v11
    v_fma_f32 v241, v241, v11, v11
    v_fma_f32 v242, v242, v11, v11
    ds_read_b128 a[4:7], v5 offset:17408
    v_mfma_f32_32x32x16_bf16 v[188:203], a[12:15], a[124:127], v[188:203]
    v_fma_f32 v243, v243, v11, v11
    v_rcp_f32 v236, v236
    ds_read_b128 a[8:11], v5 offset:18432
    s_waitcnt lgkmcnt(4)
    v_mfma_f32_32x32x16_bf16 v[172:187], a[16:19], a[128:131], v[172:187]
    s_add_u32 s43, s41, 139264
    buffer_load_dwordx4 v[56:59], v2, s[24:27], s43 offen offset:1024
    v_rcp_f32 v237, v237
    v_rcp_f32 v238, v238
    ds_read_b128 a[12:15], v5 offset:19456
    v_mfma_f32_32x32x16_bf16 v[188:203], a[20:23], a[128:131], v[188:203]
    v_rcp_f32 v239, v239
    v_rcp_f32 v240, v240
    ds_read_b128 a[16:19], v5 offset:20480
    v_mfma_f32_32x32x16_bf16 v[172:187], a[24:27], a[132:135], v[172:187]
    v_rcp_f32 v241, v241
    v_rcp_f32 v242, v242
    ds_read_b128 a[20:23], v5 offset:21504
    s_waitcnt lgkmcnt(4)
    v_mfma_f32_32x32x16_bf16 v[188:203], a[28:31], a[132:135], v[188:203]
    s_add_u32 s43, s41, 4096
    buffer_load_dwordx4 v[60:63], v2, s[24:27], s43 offen offset:1024
    v_rcp_f32 v243, v243
    v_mul_f32 v236, v236, v164
    ds_read_b128 a[24:27], v5 offset:22528
    v_mfma_f32_32x32x16_bf16 v[172:187], a[0:3], a[136:139], v[172:187]
    v_mul_f32 v237, v237, v165
    v_mul_f32 v238, v238, v166
    v_mul_f32 v239, v239, v167
    ds_read_b128 a[28:31], v5 offset:23552
    v_mfma_f32_32x32x16_bf16 v[188:203], a[4:7], a[136:139], v[188:203]
    v_mul_f32 v240, v240, v168
    v_mul_f32 v241, v241, v169
    v_mul_f32 v242, v242, v170
    ds_read_b128 a[0:3], v5 offset:24576
    s_waitcnt lgkmcnt(4)
    v_mfma_f32_32x32x16_bf16 v[172:187], a[8:11], a[140:143], v[172:187]
    v_mfma_f32_32x32x16_bf16 v[172:187], v[226:229], v[248:251], v[172:187]
    s_add_u32 s43, s41, 118784
    buffer_load_dwordx4 v[64:67], v2, s[24:27], s43 offen offset:1024
    v_mul_f32 v243, v243, v171
    v_cvt_pk_bf16_f32 v244, v236, v237
    v_cvt_pk_bf16_f32 v245, v238, v239
    ds_read_b128 a[4:7], v5 offset:25600
    v_mfma_f32_32x32x16_bf16 v[188:203], a[12:15], a[140:143], v[188:203]
    v_mfma_f32_32x32x16_bf16 v[188:203], v[228:231], v[248:251], v[188:203]
    v_cvt_pk_bf16_f32 v246, v240, v241
    v_cvt_pk_bf16_f32 v247, v242, v243
    buffer_store_dwordx4 v[244:247], v2, s[24:27], s9 offen offset:2048 sc1
    ds_read_b128 a[8:11], v5 offset:26624
    v_mfma_f32_32x32x16_bf16 v[204:219], a[16:19], a[32:35], 0
    ds_read_b128 a[12:15], v5 offset:27648
    s_waitcnt lgkmcnt(4)
    v_mfma_f32_32x32x16_bf16 v[204:219], a[20:23], a[36:39], v[204:219]
    s_add_u32 s43, s41, 12288
    buffer_load_dwordx4 v[68:71], v2, s[24:27], s43 offen offset:0
    s_waitcnt vmcnt(40)
    s_barrier
    ds_read_b128 a[16:19], v2 offset:0
    v_mfma_f32_32x32x16_bf16 v[204:219], a[24:27], a[40:43], v[204:219]
    v_mul_f32 v236, v8, v172
    v_mul_f32 v237, v8, v173
    v_mul_f32 v238, v8, v174
    ds_read_b128 a[20:23], v2 offset:1024
    v_mfma_f32_32x32x16_bf16 v[204:219], a[28:31], a[44:47], v[204:219]
    v_mul_f32 v239, v8, v175
    v_mul_f32 v240, v8, v176
    v_mul_f32 v241, v8, v177
    ds_read_b128 a[24:27], v2 offset:2048
    s_waitcnt lgkmcnt(4)
    v_mfma_f32_32x32x16_bf16 v[204:219], a[0:3], a[48:51], v[204:219]
    s_add_u32 s43, s41, 126976
    buffer_load_dwordx4 v[72:75], v2, s[24:27], s43 offen offset:0
    v_mul_f32 v242, v8, v178
    v_mul_f32 v243, v8, v179
    v_exp_f32 v236, v236
    ds_read_b128 a[28:31], v2 offset:3072
    v_mfma_f32_32x32x16_bf16 v[204:219], a[4:7], a[52:55], v[204:219]
    v_exp_f32 v237, v237
    v_exp_f32 v238, v238
    ds_read_b128 a[0:3], v2 offset:4096
    v_mfma_f32_32x32x16_bf16 v[204:219], a[8:11], a[56:59], v[204:219]
    v_exp_f32 v239, v239
    v_exp_f32 v240, v240
    ds_read_b128 a[4:7], v2 offset:5120
    s_waitcnt lgkmcnt(4)
    v_mfma_f32_32x32x16_bf16 v[204:219], a[12:15], a[60:63], v[204:219]
    s_add_u32 s43, s41, 16384
    buffer_load_dwordx4 v[76:79], v2, s[24:27], s43 offen offset:3072
    v_exp_f32 v241, v241
    v_exp_f32 v242, v242
    ds_read_b128 a[8:11], v2 offset:6144
    v_mfma_f32_32x32x16_bf16 v[204:219], a[16:19], a[64:67], v[204:219]
    v_exp_f32 v243, v243
    v_fma_f32 v236, v236, v11, v11
    ds_read_b128 a[12:15], v2 offset:7168
    v_mfma_f32_32x32x16_bf16 v[204:219], a[20:23], a[68:71], v[204:219]
    v_fma_f32 v237, v237, v11, v11
    v_fma_f32 v238, v238, v11, v11
    v_fma_f32 v239, v239, v11, v11
    ds_read_b128 a[16:19], v2 offset:8192
    s_waitcnt lgkmcnt(4)
    v_mfma_f32_32x32x16_bf16 v[204:219], a[24:27], a[72:75], v[204:219]
    s_add_u32 s43, s41, 131072
    buffer_load_dwordx4 v[80:83], v2, s[24:27], s43 offen offset:3072
    v_fma_f32 v240, v240, v11, v11
    v_fma_f32 v241, v241, v11, v11
    v_fma_f32 v242, v242, v11, v11
    ds_read_b128 a[20:23], v2 offset:9216
    v_mfma_f32_32x32x16_bf16 v[204:219], a[28:31], a[76:79], v[204:219]
    v_fma_f32 v243, v243, v11, v11
    v_rcp_f32 v236, v236
    ds_read_b128 a[24:27], v2 offset:10240
    v_mfma_f32_32x32x16_bf16 v[204:219], a[0:3], a[80:83], v[204:219]
    v_rcp_f32 v237, v237
    v_rcp_f32 v238, v238
    ds_read_b128 a[28:31], v2 offset:11264
    s_waitcnt lgkmcnt(4)
    v_mfma_f32_32x32x16_bf16 v[204:219], a[4:7], a[84:87], v[204:219]
    s_add_u32 s43, s41, 24576
    buffer_load_dwordx4 v[84:87], v2, s[24:27], s43 offen offset:2048
    v_rcp_f32 v239, v239
    v_rcp_f32 v240, v240
    ds_read_b128 a[0:3], v2 offset:12288
    v_mfma_f32_32x32x16_bf16 v[204:219], a[8:11], a[88:91], v[204:219]
    v_rcp_f32 v241, v241
    v_rcp_f32 v242, v242
    ds_read_b128 a[4:7], v2 offset:13312
    v_mfma_f32_32x32x16_bf16 v[204:219], a[12:15], a[92:95], v[204:219]
    v_rcp_f32 v243, v243
    v_mul_f32 v236, v236, v180
    ds_read_b128 a[8:11], v2 offset:14336
    s_waitcnt lgkmcnt(4)
    v_mfma_f32_32x32x16_bf16 v[204:219], a[16:19], a[96:99], v[204:219]
    s_add_u32 s43, s41, 139264
    buffer_load_dwordx4 v[88:91], v2, s[24:27], s43 offen offset:2048
    v_mul_f32 v237, v237, v181
    v_mul_f32 v238, v238, v182
    v_mul_f32 v239, v239, v183
    ds_read_b128 a[12:15], v2 offset:15360
    v_mfma_f32_32x32x16_bf16 v[204:219], a[20:23], a[100:103], v[204:219]
    v_mul_f32 v240, v240, v184
    v_mul_f32 v241, v241, v185
    v_mul_f32 v242, v242, v186
    s_waitcnt vmcnt(6)
    s_barrier
    s_cmp_lg_u32 s3, 0
    s_cbranch_scc1 KB_sig0
    v_mov_b32 v6, 1
    s_mov_b64 exec, 1
    buffer_atomic_add v6, v9, s[24:27], s42 offen offset:0 sc1
    s_mov_b64 exec, -1
KB_sig0:
    ds_read_b128 a[16:19], v2 offset:16384
    v_mfma_f32_32x32x16_bf16 v[204:219], a[24:27], a[104:107], v[204:219]
    v_mul_f32 v243, v243, v187
    v_cvt_pk_bf16_f32 v244, v236, v237
    v_cvt_pk_bf16_f32 v245, v238, v239
    ds_read_b128 a[20:23], v2 offset:17408
    s_waitcnt lgkmcnt(4)
    v_mfma_f32_32x32x16_bf16 v[204:219], a[28:31], a[108:111], v[204:219]
    s_add_u32 s43, s41, 4096
    buffer_load_dwordx4 v[92:95], v2, s[24:27], s43 offen offset:2048
    v_cvt_pk_bf16_f32 v246, v240, v241
    v_cvt_pk_bf16_f32 v247, v242, v243
    buffer_store_dwordx4 v[244:247], v2, s[24:27], s9 offen offset:3072 sc1
    ds_read_b128 a[24:27], v2 offset:18432
    v_mfma_f32_32x32x16_bf16 v[204:219], a[0:3], a[112:115], v[204:219]
    v_mul_f32 v236, v8, v188
    v_mul_f32 v237, v8, v189
    v_mul_f32 v238, v8, v190
    ds_read_b128 a[28:31], v2 offset:19456
    v_mfma_f32_32x32x16_bf16 v[204:219], a[4:7], a[116:119], v[204:219]
    v_mul_f32 v239, v8, v191
    v_mul_f32 v240, v8, v192
    v_mul_f32 v241, v8, v193
    ds_read_b128 a[0:3], v2 offset:20480
    s_waitcnt lgkmcnt(4)
    v_mfma_f32_32x32x16_bf16 v[204:219], a[8:11], a[120:123], v[204:219]
    s_add_u32 s43, s41, 118784
    buffer_load_dwordx4 v[96:99], v2, s[24:27], s43 offen offset:2048
    v_mul_f32 v242, v8, v194
    v_mul_f32 v243, v8, v195
    v_exp_f32 v236, v236
    ds_read_b128 a[4:7], v2 offset:21504
    v_mfma_f32_32x32x16_bf16 v[204:219], a[12:15], a[124:127], v[204:219]
    v_exp_f32 v237, v237
    v_exp_f32 v238, v238
    ds_read_b128 a[8:11], v2 offset:22528
    v_mfma_f32_32x32x16_bf16 v[204:219], a[16:19], a[128:131], v[204:219]
    v_exp_f32 v239, v239
    v_exp_f32 v240, v240
    ds_read_b128 a[12:15], v2 offset:23552
    s_waitcnt lgkmcnt(4)
    v_mfma_f32_32x32x16_bf16 v[204:219], a[20:23], a[132:135], v[204:219]
    s_add_u32 s43, s41, 12288
    buffer_load_dwordx4 v[100:103], v2, s[24:27], s43 offen offset:1024
    v_exp_f32 v241, v241
    v_exp_f32 v242, v242
    ds_read_b128 a[16:19], v2 offset:24576
    v_mfma_f32_32x32x16_bf16 v[204:219], a[24:27], a[136:139], v[204:219]
    v_exp_f32 v243, v243
    v_fma_f32 v236, v236, v11, v11
    ds_read_b128 a[20:23], v2 offset:25600
    v_mfma_f32_32x32x16_bf16 v[204:219], a[28:31], a[140:143], v[204:219]
    v_mfma_f32_32x32x16_bf16 v[204:219], v[230:233], v[248:251], v[204:219]
    v_fma_f32 v237, v237, v11, v11
    v_fma_f32 v238, v238, v11, v11
    v_fma_f32 v239, v239, v11, v11
    ds_read_b128 a[24:27], v2 offset:26624
    s_waitcnt lgkmcnt(4)
    v_mfma_f32_32x32x16_bf16 v[124:139], a[0:3], a[32:35], 0
    s_add_u32 s43, s41, 126976
    buffer_load_dwordx4 v[104:107], v2, s[24:27], s43 offen offset:1024
    v_fma_f32 v240, v240, v11, v11
    v_fma_f32 v241, v241, v11, v11
    v_fma_f32 v242, v242, v11, v11
    ds_read_b128 a[28:31], v2 offset:27648
    v_mfma_f32_32x32x16_bf16 v[124:139], a[4:7], a[36:39], v[124:139]
    v_fma_f32 v243, v243, v11, v11
    v_rcp_f32 v236, v236
    ds_read_b128 a[0:3], v2 offset:28672
    v_mfma_f32_32x32x16_bf16 v[124:139], a[8:11], a[40:43], v[124:139]
    v_rcp_f32 v237, v237
    v_rcp_f32 v238, v238
    ds_read_b128 a[4:7], v2 offset:29696
    s_waitcnt lgkmcnt(4)
    v_mfma_f32_32x32x16_bf16 v[124:139], a[12:15], a[44:47], v[124:139]
    s_add_u32 s43, s41, 20480
    buffer_load_dwordx4 v[108:111], v2, s[24:27], s43 offen offset:0
    v_rcp_f32 v239, v239
    v_rcp_f32 v240, v240
    ds_read_b128 a[8:11], v2 offset:30720
    v_mfma_f32_32x32x16_bf16 v[124:139], a[16:19], a[48:51], v[124:139]
    v_rcp_f32 v241, v241
    v_rcp_f32 v242, v242
    ds_read_b128 a[12:15], v2 offset:31744
    v_mfma_f32_32x32x16_bf16 v[124:139], a[20:23], a[52:55], v[124:139]
    v_rcp_f32 v243, v243
    v_mul_f32 v236, v236, v196
    s_barrier
    ds_read_b128 a[16:19], v2 offset:32768
    s_waitcnt lgkmcnt(4)
    v_mfma_f32_32x32x16_bf16 v[124:139], a[24:27], a[56:59], v[124:139]
    s_add_u32 s43, s41, 135168
    buffer_load_dwordx4 v[112:115], v2, s[24:27], s43 offen offset:0
    v_mul_f32 v237, v237, v197
    v_mul_f32 v238, v238, v198
    v_mul_f32 v239, v239, v199
    ds_read_b128 a[20:23], v2 offset:33792
    v_mfma_f32_32x32x16_bf16 v[124:139], a[28:31], a[60:63], v[124:139]
    v_mul_f32 v240, v240, v200
    v_mul_f32 v241, v241, v201
    v_mul_f32 v242, v242, v202
    ds_read_b128 a[24:27], v2 offset:34816
    v_mfma_f32_32x32x16_bf16 v[124:139], a[0:3], a[64:67], v[124:139]
    v_mul_f32 v243, v243, v203
    v_cvt_pk_bf16_f32 v244, v236, v237
    v_cvt_pk_bf16_f32 v245, v238, v239
    ds_read_b128 a[28:31], v2 offset:35840
    s_waitcnt lgkmcnt(4)
    v_mfma_f32_32x32x16_bf16 v[124:139], a[4:7], a[68:71], v[124:139]
    s_add_u32 s43, s41, 24576
    buffer_load_dwordx4 v[116:119], v2, s[24:27], s43 offen offset:3072
    v_cvt_pk_bf16_f32 v246, v240, v241
    v_cvt_pk_bf16_f32 v247, v242, v243
    buffer_store_dwordx4 v[244:247], v2, s[24:27], s14 offen offset:0 sc1
    ds_read_b128 a[0:3], v2 offset:36864
    v_mfma_f32_32x32x16_bf16 v[124:139], a[8:11], a[72:75], v[124:139]
    v_mul_f32 v236, v8, v204
    v_mul_f32 v237, v8, v205
    v_mul_f32 v238, v8, v206
    ds_read_b128 a[4:7], v2 offset:37888
    v_mfma_f32_32x32x16_bf16 v[124:139], a[12:15], a[76:79], v[124:139]
    v_mul_f32 v239, v8, v207
    v_mul_f32 v240, v8, v208
    v_mul_f32 v241, v8, v209
    ds_read_b128 a[8:11], v2 offset:38912
    s_waitcnt lgkmcnt(4)
    v_mfma_f32_32x32x16_bf16 v[124:139], a[16:19], a[80:83], v[124:139]
    s_add_u32 s43, s41, 139264
    buffer_load_dwordx4 v[120:123], v2, s[24:27], s43 offen offset:3072
    v_mul_f32 v242, v8, v210
    v_mul_f32 v243, v8, v211
    v_exp_f32 v236, v236
    ds_read_b128 a[12:15], v2 offset:39936
    v_mfma_f32_32x32x16_bf16 v[124:139], a[20:23], a[84:87], v[124:139]
    v_exp_f32 v237, v237
    v_exp_f32 v238, v238
    ds_read_b128 a[16:19], v2 offset:40960
    v_mfma_f32_32x32x16_bf16 v[124:139], a[24:27], a[88:91], v[124:139]
    v_exp_f32 v239, v239
    v_exp_f32 v240, v240
    ds_read_b128 a[20:23], v2 offset:41984
    s_waitcnt lgkmcnt(4)
    v_mfma_f32_32x32x16_bf16 v[124:139], a[28:31], a[92:95], v[124:139]
    v_exp_f32 v241, v241
    v_exp_f32 v242, v242
    ds_read_b128 a[24:27], v2 offset:43008
    v_mfma_f32_32x32x16_bf16 v[124:139], a[0:3], a[96:99], v[124:139]
    v_exp_f32 v243, v243
    v_fma_f32 v236, v236, v11, v11
    ds_read_b128 a[28:31], v2 offset:44032
    v_mfma_f32_32x32x16_bf16 v[124:139], a[4:7], a[100:103], v[124:139]
    v_fma_f32 v237, v237, v11, v11
    v_fma_f32 v238, v238, v11, v11
    v_fma_f32 v239, v239, v11, v11
    ds_read_b128 a[0:3], v2 offset:45056
    s_waitcnt lgkmcnt(4)
    v_mfma_f32_32x32x16_bf16 v[124:139], a[8:11], a[104:107], v[124:139]
    v_fma_f32 v240, v240, v11, v11
    v_fma_f32 v241, v241, v11, v11
    v_fma_f32 v242, v242, v11, v11
    ds_read_b128 a[4:7], v2 offset:46080
    v_mfma_f32_32x32x16_bf16 v[124:139], a[12:15], a[108:111], v[124:139]
    v_fma_f32 v243, v243, v11, v11
    v_rcp_f32 v236, v236
    ds_read_b128 a[8:11], v2 offset:47104
    v_mfma_f32_32x32x16_bf16 v[124:139], a[16:19], a[112:115], v[124:139]
    v_rcp_f32 v237, v237
    v_rcp_f32 v238, v238
    ds_read_b128 a[12:15], v2 offset:48128
    s_waitcnt lgkmcnt(4)
    v_mfma_f32_32x32x16_bf16 v[124:139], a[20:23], a[116:119], v[124:139]
    v_rcp_f32 v239, v239
    v_rcp_f32 v240, v240
    v_mfma_f32_32x32x16_bf16 v[124:139], a[24:27], a[120:123], v[124:139]
    buffer_load_dword v7, v9, s[24:27], s47 offen offset:0 sc1
    v_rcp_f32 v241, v241
    v_rcp_f32 v242, v242
    v_mfma_f32_32x32x16_bf16 v[124:139], a[28:31], a[124:127], v[124:139]
    v_rcp_f32 v243, v243
    v_mul_f32 v236, v236, v212
    s_waitcnt lgkmcnt(1)
    v_mfma_f32_32x32x16_bf16 v[124:139], a[0:3], a[128:131], v[124:139]
    v_mul_f32 v237, v237, v213
    v_mul_f32 v238, v238, v214
    v_mul_f32 v239, v239, v215
    v_mfma_f32_32x32x16_bf16 v[124:139], a[4:7], a[132:135], v[124:139]
    v_mul_f32 v240, v240, v216
    v_mul_f32 v241, v241, v217
    v_mul_f32 v242, v242, v218
    v_mfma_f32_32x32x16_bf16 v[124:139], a[8:11], a[136:139], v[124:139]
    v_mul_f32 v243, v243, v219
    v_cvt_pk_bf16_f32 v244, v236, v237
    v_cvt_pk_bf16_f32 v245, v238, v239
    s_waitcnt lgkmcnt(0)
    v_mfma_f32_32x32x16_bf16 v[124:139], a[12:15], a[140:143], v[124:139]
    v_mfma_f32_32x32x16_bf16 v[124:139], v[232:235], v[248:251], v[124:139]
    v_cvt_pk_bf16_f32 v246, v240, v241
    v_cvt_pk_bf16_f32 v247, v242, v243
    buffer_store_dwordx4 v[244:247], v2, s[24:27], s14 offen offset:1024 sc1
    s_waitcnt vmcnt(3)
    s_barrier
    s_cmp_lg_u32 s3, 0
    s_cbranch_scc1 KB_sig1
    v_mov_b32 v6, 1
    s_mov_b64 exec, 1
    buffer_atomic_add v6, v9, s[24:27], s42 offen offset:256 sc1
    s_mov_b64 exec, -1
KB_sig1:
    s_waitcnt vmcnt(1)
    v_readfirstlane_b32 s44, v7
    s_nop 0
    s_cmp_ge_u32 s44, 16
    s_cbranch_scc1 KB_ok0
    s_mov_b32 s45, 0
KB_spin0:
    s_sleep 4
    buffer_load_dword v7, v9, s[24:27], s47 offen offset:0 sc1
    s_waitcnt vmcnt(0)
    v_readfirstlane_b32 s44, v7
    s_add_u32 s45, s45, 1
    s_cmp_ge_u32 s45, 100000
    s_cbranch_scc1 KB_ok0
    s_cmp_lt_u32 s44, 16
    s_cbranch_scc1 KB_spin0
KB_ok0:
    s_add_u32 s43, s40, 0
    buffer_load_dwordx4 a[0:3], v2, s[24:27], s43 offen offset:0
    s_add_u32 s43, s40, 114688
    buffer_load_dwordx4 a[4:7], v2, s[24:27], s43 offen offset:0
    s_add_u32 s43, s40, 4096
    buffer_load_dwordx4 a[8:11], v2, s[24:27], s43 offen offset:3072
    s_add_u32 s43, s40, 118784
    buffer_load_dwordx4 a[12:15], v2, s[24:27], s43 offen offset:3072
    s_add_u32 s43, s40, 12288
    buffer_load_dwordx4 a[16:19], v2, s[24:27], s43 offen offset:2048
    s_add_u32 s43, s40, 126976
    buffer_load_dwordx4 a[20:23], v2, s[24:27], s43 offen offset:2048
    s_add_u32 s43, s40, 20480
    buffer_load_dwordx4 a[24:27], v2, s[24:27], s43 offen offset:1024
    s_add_u32 s43, s40, 135168
    buffer_load_dwordx4 a[28:31], v2, s[24:27], s43 offen offset:1024
    s_add_u32 s43, s40, 0
    buffer_load_dwordx4 a[32:35], v2, s[24:27], s43 offen offset:1024
    s_add_u32 s43, s40, 114688
    buffer_load_dwordx4 a[36:39], v2, s[24:27], s43 offen offset:1024
    s_add_u32 s43, s40, 8192
    buffer_load_dwordx4 a[40:43], v2, s[24:27], s43 offen offset:0
    s_add_u32 s43, s40, 122880
    buffer_load_dwordx4 a[44:47], v2, s[24:27], s43 offen offset:0
    s_add_u32 s43, s40, 12288
    buffer_load_dwordx4 a[48:51], v2, s[24:27], s43 offen offset:3072
    s_add_u32 s43, s40, 126976
    buffer_load_dwordx4 a[52:55], v2, s[24:27], s43 offen offset:3072
    v_mul_f32 v236, v8, v124
    v_mul_f32 v237, v8, v125
    v_mul_f32 v238, v8, v126
    v_mul_f32 v239, v8, v127
    v_mul_f32 v240, v8, v128
    v_mul_f32 v241, v8, v129
    v_mul_f32 v242, v8, v130
    v_mul_f32 v243, v8, v131
    v_exp_f32 v236, v236
    v_exp_f32 v237, v237
    v_exp_f32 v238, v238
    v_exp_f32 v239, v239
    v_exp_f32 v240, v240
    v_exp_f32 v241, v241
    v_exp_f32 v242, v242
    v_exp_f32 v243, v243
    v_fma_f32 v236, v236, v11, v11
    v_fma_f32 v237, v237, v11, v11
    v_fma_f32 v238, v238, v11, v11
    v_fma_f32 v239, v239, v11, v11
    v_fma_f32 v240, v240, v11, v11
    v_fma_f32 v241, v241, v11, v11
    v_fma_f32 v242, v242, v11, v11
    v_fma_f32 v243, v243, v11, v11
    v_rcp_f32 v236, v236
    v_rcp_f32 v237, v237
    v_rcp_f32 v238, v238
    v_rcp_f32 v239, v239
    v_rcp_f32 v240, v240
    v_rcp_f32 v241, v241
    v_rcp_f32 v242, v242
    v_rcp_f32 v243, v243
    v_mul_f32 v236, v236, v132
    v_mul_f32 v237, v237, v133
    v_mul_f32 v238, v238, v134
    v_mul_f32 v239, v239, v135
    v_mul_f32 v240, v240, v136
    v_mul_f32 v241, v241, v137
    v_mul_f32 v242, v242, v138
    v_mul_f32 v243, v243, v139
    v_cvt_pk_bf16_f32 v244, v236, v237
    v_cvt_pk_bf16_f32 v245, v238, v239
    v_cvt_pk_bf16_f32 v246, v240, v241
    v_cvt_pk_bf16_f32 v247, v242, v243
    buffer_store_dwordx4 v[244:247], v2, s[24:27], s14 offen offset:2048 sc1
    s_cmp_ge_u32 s31, 28
    s_cbranch_scc0 KB_p4
    s_waitcnt vmcnt(0)
    s_barrier
    s_cmp_lg_u32 s3, 0
    s_cbranch_scc1 KB_sig2i
    v_mov_b32 v6, 1
    s_mov_b64 exec, 1
    buffer_atomic_add v6, v9, s[24:27], s42 offen offset:512 sc1
    s_mov_b64 exec, -1
KB_sig2i:
    s_branch KB_fin
KB_p4:
    s_lshr_b32 s32, s3, 1
    s_lshl_b32 s33, s16, 1
    s_add_u32 s32, s32, s33
    s_and_b32 s34, s3, 1
    s_lshl_b32 s33, s17, 1
    s_add_u32 s34, s34, s33
    s_mul_i32 s46, s32, 28672
    s_add_u32 s46, s46, 0x1000000
    s_lshl_b32 s32, s32, 5
    v_and_b32 v132, 31, v1
    v_add_u32 v3, s32, v132
    v_mul_u32_u24 v3, 896, v3
    v_lshrrev_b32 v4, 5, v1
    v_lshl_add_u32 v3, v4, 5, v3
    s_lshl_b32 s33, s34, 6
    v_add_u32 v3, s33, v3
    s_lshl_b32 s33, s34, 5
    v_lshl_add_u32 v133, v4, 4, s33
    v_lshlrev_b32 v132, 4, v132
    s_movk_i32 s56, 4682
    buffer_load_dword v7, v9, s[24:27], s47 offen offset:256 sc1
    s_waitcnt vmcnt(14)
    v_mfma_f32_32x32x16_bf16 a[64:79], a[144:147], a[0:3], 0
    v_mfma_f32_32x32x16_bf16 a[80:95], a[148:151], a[0:3], 0
    s_add_u32 s43, s40, 20480
    buffer_load_dwordx4 a[56:59], v2, s[24:27], s43 offen offset:2048
    v_mfma_f32_32x32x16_bf16 a[96:111], a[144:147], a[4:7], 0
    v_mfma_f32_32x32x16_bf16 a[112:127], a[148:151], a[4:7], 0
    s_add_u32 s43, s40, 135168
    buffer_load_dwordx4 a[60:63], v2, s[24:27], s43 offen offset:2048
    s_waitcnt vmcnt(14)
    v_mfma_f32_32x32x16_bf16 a[64:79], a[152:155], a[8:11], a[64:79]
    v_mfma_f32_32x32x16_bf16 a[80:95], a[156:159], a[8:11], a[80:95]
    s_add_u32 s43, s40, 0
    buffer_load_dwordx4 a[0:3], v2, s[24:27], s43 offen offset:2048
    v_mfma_f32_32x32x16_bf16 a[96:111], a[152:155], a[12:15], a[96:111]
    v_mfma_f32_32x32x16_bf16 a[112:127], a[156:159], a[12:15], a[112:127]
    s_add_u32 s43, s40, 114688
    buffer_load_dwordx4 a[4:7], v2, s[24:27], s43 offen offset:2048
    s_waitcnt vmcnt(14)
    v_mfma_f32_32x32x16_bf16 a[64:79], a[160:163], a[16:19], a[64:79]
    v_mfma_f32_32x32x16_bf16 a[80:95], a[164:167], a[16:19], a[80:95]
    s_add_u32 s43, s40, 8192
    buffer_load_dwordx4 a[8:11], v2, s[24:27], s43 offen offset:1024
    v_mfma_f32_32x32x16_bf16 a[96:111], a[160:163], a[20:23], a[96:111]
    v_mfma_f32_32x32x16_bf16 a[112:127], a[164:167], a[20:23], a[112:127]
    s_add_u32 s43, s40, 122880
    buffer_load_dwordx4 a[12:15], v2, s[24:27], s43 offen offset:1024
    s_waitcnt vmcnt(14)
    s_waitcnt vmcnt(7)
    s_barrier
    s_cmp_lg_u32 s3, 0
    s_cbranch_scc1 KB_sig2
    v_mov_b32 v6, 1
    s_mov_b64 exec, 1
    buffer_atomic_add v6, v9, s[24:27], s42 offen offset:512 sc1
    s_mov_b64 exec, -1
KB_sig2:
    v_mfma_f32_32x32x16_bf16 a[64:79], a[168:171], a[24:27], a[64:79]
    v_mfma_f32_32x32x16_bf16 a[80:95], a[172:175], a[24:27], a[80:95]
    s_add_u32 s43, s40, 16384
    buffer_load_dwordx4 a[16:19], v2, s[24:27], s43 offen offset:0
    v_mfma_f32_32x32x16_bf16 a[96:111], a[168:171], a[28:31], a[96:111]
    v_mfma_f32_32x32x16_bf16 a[112:127], a[172:175], a[28:31], a[112:127]
    s_add_u32 s43, s40, 131072
    buffer_load_dwordx4 a[20:23], v2, s[24:27], s43 offen offset:0
    v_mfma_f32_32x32x16_bf16 a[64:79], a[176:179], a[32:35], a[64:79]
    v_mfma_f32_32x32x16_bf16 a[80:95], a[180:183], a[32:35], a[80:95]
    s_add_u32 s43, s40, 20480
    buffer_load_dwordx4 a[24:27], v2, s[24:27], s43 offen offset:3072
    v_mfma_f32_32x32x16_bf16 a[96:111], a[176:179], a[36:39], a[96:111]
    v_mfma_f32_32x32x16_bf16 a[112:127], a[180:183], a[36:39], a[112:127]
    s_add_u32 s43, s40, 135168
    buffer_load_dwordx4 a[28:31], v2, s[24:27], s43 offen offset:3072
    s_waitcnt vmcnt(10)
    v_readfirstlane_b32 s44, v7
    s_nop 0
    s_cmp_ge_u32 s44, 16
    s_cbranch_scc1 KB_ok1
    s_mov_b32 s45, 0
KB_spin1:
    s_sleep 4
    buffer_load_dword v7, v9, s[24:27], s47 offen offset:256 sc1
    s_waitcnt vmcnt(0)
    v_readfirstlane_b32 s44, v7
    s_add_u32 s45, s45, 1
    s_cmp_ge_u32 s45, 100000
    s_cbranch_scc1 KB_ok1
    s_cmp_lt_u32 s44, 16
    s_cbranch_scc1 KB_spin1
KB_ok1:
    v_mfma_f32_32x32x16_bf16 a[64:79], a[184:187], a[40:43], a[64:79]
    v_mfma_f32_32x32x16_bf16 a[80:95], a[188:191], a[40:43], a[80:95]
    s_add_u32 s43, s40, 0
    buffer_load_dwordx4 a[32:35], v2, s[24:27], s43 offen offset:3072
    v_mfma_f32_32x32x16_bf16 a[96:111], a[184:187], a[44:47], a[96:111]
    v_mfma_f32_32x32x16_bf16 a[112:127], a[188:191], a[44:47], a[112:127]
    s_add_u32 s43, s40, 114688
    buffer_load_dwordx4 a[36:39], v2, s[24:27], s43 offen offset:3072
    v_mfma_f32_32x32x16_bf16 a[64:79], a[192:195], a[48:51], a[64:79]
    v_mfma_f32_32x32x16_bf16 a[80:95], a[196:199], a[48:51], a[80:95]
    s_add_u32 s43, s40, 8192
    buffer_load_dwordx4 a[40:43], v2, s[24:27], s43 offen offset:2048
    v_mfma_f32_32x32x16_bf16 a[96:111], a[192:195], a[52:55], a[96:111]
    v_mfma_f32_32x32x16_bf16 a[112:127], a[196:199], a[52:55], a[112:127]
    s_add_u32 s43, s40, 122880
    buffer_load_dwordx4 a[44:47], v2, s[24:27], s43 offen offset:2048
    s_waitcnt vmcnt(12)
    v_mfma_f32_32x32x16_bf16 a[64:79], a[200:203], a[56:59], a[64:79]
    v_mfma_f32_32x32x16_bf16 a[80:95], a[204:207], a[56:59], a[80:95]
    s_add_u32 s43, s40, 16384
    buffer_load_dwordx4 a[48:51], v2, s[24:27], s43 offen offset:1024
    v_mfma_f32_32x32x16_bf16 a[96:111], a[200:203], a[60:63], a[96:111]
    v_mfma_f32_32x32x16_bf16 a[112:127], a[204:207], a[60:63], a[112:127]
    s_add_u32 s43, s40, 131072
    buffer_load_dwordx4 a[52:55], v2, s[24:27], s43 offen offset:1024
    s_waitcnt vmcnt(12)
    v_mfma_f32_32x32x16_bf16 a[64:79], a[208:211], a[0:3], a[64:79]
    v_mfma_f32_32x32x16_bf16 a[80:95], a[212:215], a[0:3], a[80:95]
    s_add_u32 s43, s40, 24576
    buffer_load_dwordx4 a[56:59], v2, s[24:27], s43 offen offset:0
    v_mfma_f32_32x32x16_bf16 a[96:111], a[208:211], a[4:7], a[96:111]
    v_mfma_f32_32x32x16_bf16 a[112:127], a[212:215], a[4:7], a[112:127]
    s_add_u32 s43, s40, 139264
    buffer_load_dwordx4 a[60:63], v2, s[24:27], s43 offen offset:0
    buffer_load_dword v8, v9, s[24:27], s47 offen offset:512 sc1
    s_waitcnt vmcnt(13)
    v_mfma_f32_32x32x16_bf16 a[64:79], a[216:219], a[8:11], a[64:79]
    v_mfma_f32_32x32x16_bf16 a[80:95], a[220:223], a[8:11], a[80:95]
    s_add_u32 s43, s40, 4096
    buffer_load_dwordx4 a[0:3], v2, s[24:27], s43 offen offset:0
    v_mfma_f32_32x32x16_bf16 a[96:111], a[216:219], a[12:15], a[96:111]
    v_mfma_f32_32x32x16_bf16 a[112:127], a[220:223], a[12:15], a[112:127]
    s_add_u32 s43, s40, 118784
    buffer_load_dwordx4 a[4:7], v2, s[24:27], s43 offen offset:0
    s_waitcnt vmcnt(13)
    v_mfma_f32_32x32x16_bf16 a[64:79], a[224:227], a[16:19], a[64:79]
    v_mfma_f32_32x32x16_bf16 a[80:95], a[228:231], a[16:19], a[80:95]
    s_add_u32 s43, s40, 8192
    buffer_load_dwordx4 a[8:11], v2, s[24:27], s43 offen offset:3072
    v_mfma_f32_32x32x16_bf16 a[96:111], a[224:227], a[20:23], a[96:111]
    v_mfma_f32_32x32x16_bf16 a[112:127], a[228:231], a[20:23], a[112:127]
    s_add_u32 s43, s40, 122880
    buffer_load_dwordx4 a[12:15], v2, s[24:27], s43 offen offset:3072
    s_waitcnt vmcnt(13)
    v_mfma_f32_32x32x16_bf16 a[64:79], a[232:235], a[24:27], a[64:79]
    v_mfma_f32_32x32x16_bf16 a[80:95], a[236:239], a[24:27], a[80:95]
    s_add_u32 s43, s40, 16384
    buffer_load_dwordx4 a[16:19], v2, s[24:27], s43 offen offset:2048
    v_mfma_f32_32x32x16_bf16 a[96:111], a[232:235], a[28:31], a[96:111]
    v_mfma_f32_32x32x16_bf16 a[112:127], a[236:239], a[28:31], a[112:127]
    s_add_u32 s43, s40, 131072
    buffer_load_dwordx4 a[20:23], v2, s[24:27], s43 offen offset:2048
    s_waitcnt vmcnt(13)
    v_mfma_f32_32x32x16_bf16 a[64:79], a[240:243], a[32:35], a[64:79]
    v_mfma_f32_32x32x16_bf16 a[80:95], a[244:247], a[32:35], a[80:95]
    s_add_u32 s43, s40, 24576
    buffer_load_dwordx4 a[24:27], v2, s[24:27], s43 offen offset:1024
    v_mfma_f32_32x32x16_bf16 a[96:111], a[240:243], a[36:39], a[96:111]
    v_mfma_f32_32x32x16_bf16 a[112:127], a[244:247], a[36:39], a[112:127]
    s_add_u32 s43, s40, 139264
    buffer_load_dwordx4 a[28:31], v2, s[24:27], s43 offen offset:1024
    s_waitcnt vmcnt(8)
    v_readfirstlane_b32 s44, v8
    s_nop 0
    s_cmp_ge_u32 s44, 16
    s_cbranch_scc1 KB_ok2
    s_mov_b32 s45, 0
KB_spin2:
    s_sleep 4
    buffer_load_dword v8, v9, s[24:27], s47 offen offset:512 sc1
    s_waitcnt vmcnt(0)
    v_readfirstlane_b32 s44, v8
    s_add_u32 s45, s45, 1
    s_cmp_ge_u32 s45, 100000
    s_cbranch_scc1 KB_ok2
    s_cmp_lt_u32 s44, 16
    s_cbranch_scc1 KB_spin2
KB_ok2:
    v_mfma_f32_32x32x16_bf16 a[64:79], a[248:251], a[40:43], a[64:79]
    v_mfma_f32_32x32x16_bf16 a[80:95], a[252:255], a[40:43], a[80:95]
    s_add_u32 s43, s40, 4096
    buffer_load_dwordx4 a[32:35], v2, s[24:27], s43 offen offset:1024
    v_mfma_f32_32x32x16_bf16 a[96:111], a[248:251], a[44:47], a[96:111]
    v_mfma_f32_32x32x16_bf16 a[112:127], a[252:255], a[44:47], a[112:127]
    s_add_u32 s43, s40, 118784
    buffer_load_dwordx4 a[36:39], v2, s[24:27], s43 offen offset:1024
    v_mfma_f32_32x32x16_bf16 a[64:79], v[12:15], a[48:51], a[64:79]
    v_mfma_f32_32x32x16_bf16 a[80:95], v[16:19], a[48:51], a[80:95]
    s_add_u32 s43, s40, 12288
    buffer_load_dwordx4 a[40:43], v2, s[24:27], s43 offen offset:0
    v_mfma_f32_32x32x16_bf16 a[96:111], v[12:15], a[52:55], a[96:111]
    v_mfma_f32_32x32x16_bf16 a[112:127], v[16:19], a[52:55], a[112:127]
    s_add_u32 s43, s40, 126976
    buffer_load_dwordx4 a[44:47], v2, s[24:27], s43 offen offset:0
    v_mfma_f32_32x32x16_bf16 a[64:79], v[20:23], a[56:59], a[64:79]
    v_mfma_f32_32x32x16_bf16 a[80:95], v[24:27], a[56:59], a[80:95]
    s_add_u32 s43, s40, 16384
    buffer_load_dwordx4 a[48:51], v2, s[24:27], s43 offen offset:3072
    v_mfma_f32_32x32x16_bf16 a[96:111], v[20:23], a[60:63], a[96:111]
    v_mfma_f32_32x32x16_bf16 a[112:127], v[24:27], a[60:63], a[112:127]
    s_add_u32 s43, s40, 131072
    buffer_load_dwordx4 a[52:55], v2, s[24:27], s43 offen offset:3072
    s_waitcnt vmcnt(12)
    v_mfma_f32_32x32x16_bf16 a[64:79], v[28:31], a[0:3], a[64:79]
    v_mfma_f32_32x32x16_bf16 a[80:95], v[32:35], a[0:3], a[80:95]
    s_add_u32 s43, s40, 24576
    buffer_load_dwordx4 a[56:59], v2, s[24:27], s43 offen offset:2048
    v_mfma_f32_32x32x16_bf16 a[96:111], v[28:31], a[4:7], a[96:111]
    v_mfma_f32_32x32x16_bf16 a[112:127], v[32:35], a[4:7], a[112:127]
    s_add_u32 s43, s40, 139264
    buffer_load_dwordx4 a[60:63], v2, s[24:27], s43 offen offset:2048
    s_waitcnt vmcnt(12)
    v_mfma_f32_32x32x16_bf16 a[64:79], v[36:39], a[8:11], a[64:79]
    v_mfma_f32_32x32x16_bf16 a[80:95], v[40:43], a[8:11], a[80:95]
    s_add_u32 s43, s40, 4096
    buffer_load_dwordx4 a[0:3], v2, s[24:27], s43 offen offset:2048
    v_mfma_f32_32x32x16_bf16 a[96:111], v[36:39], a[12:15], a[96:111]
    v_mfma_f32_32x32x16_bf16 a[112:127], v[40:43], a[12:15], a[112:127]
    s_add_u32 s43, s40, 118784
    buffer_load_dwordx4 a[4:7], v2, s[24:27], s43 offen offset:2048
    s_waitcnt vmcnt(12)
    v_mfma_f32_32x32x16_bf16 a[64:79], v[44:47], a[16:19], a[64:79]
    v_mfma_f32_32x32x16_bf16 a[80:95], v[48:51], a[16:19], a[80:95]
    s_add_u32 s43, s40, 12288
    buffer_load_dwordx4 a[8:11], v2, s[24:27], s43 offen offset:1024
    v_mfma_f32_32x32x16_bf16 a[96:111], v[44:47], a[20:23], a[96:111]
    v_mfma_f32_32x32x16_bf16 a[112:127], v[48:51], a[20:23], a[112:127]
    s_add_u32 s43, s40, 126976
    buffer_load_dwordx4 a[12:15], v2, s[24:27], s43 offen offset:1024
    s_waitcnt vmcnt(12)
    v_mfma_f32_32x32x16_bf16 a[64:79], v[52:55], a[24:27], a[64:79]
    v_mfma_f32_32x32x16_bf16 a[80:95], v[56:59], a[24:27], a[80:95]
    s_add_u32 s43, s40, 20480
    buffer_load_dwordx4 a[16:19], v2, s[24:27], s43 offen offset:0
    v_mfma_f32_32x32x16_bf16 a[96:111], v[52:55], a[28:31], a[96:111]
    v_mfma_f32_32x32x16_bf16 a[112:127], v[56:59], a[28:31], a[112:127]
    s_add_u32 s43, s40, 135168
    buffer_load_dwordx4 a[20:23], v2, s[24:27], s43 offen offset:0
    s_waitcnt vmcnt(12)
    v_mfma_f32_32x32x16_bf16 a[64:79], v[60:63], a[32:35], a[64:79]
    v_mfma_f32_32x32x16_bf16 a[80:95], v[64:67], a[32:35], a[80:95]
    s_add_u32 s43, s40, 24576
    buffer_load_dwordx4 a[24:27], v2, s[24:27], s43 offen offset:3072
    v_mfma_f32_32x32x16_bf16 a[96:111], v[60:63], a[36:39], a[96:111]
    v_mfma_f32_32x32x16_bf16 a[112:127], v[64:67], a[36:39], a[112:127]
    s_add_u32 s43, s40, 139264
    buffer_load_dwordx4 a[28:31], v2, s[24:27], s43 offen offset:3072
    v_add_u32 v134, 0, v133
    v_mul_u32_u24 v135, s56, v134
    v_lshrrev_b32 v135, 16, v135
    v_mul_u32_u24 v136, 14, v135
    v_sub_u32 v136, v134, v136
    v_lshrrev_b32 v137, 1, v135
    v_mad_u32_u24 v136, v137, 14, v136
    v_and_b32 v135, 1, v135
    v_lshrrev_b32 v137, 3, v136
    v_lshl_add_u32 v137, v137, 10, v132
    v_lshl_add_u32 v137, v135, 9, v137
    v_and_b32 v136, 7, v136
    v_lshl_add_u32 v137, v136, 1, v137
    buffer_load_dword v124, v137, s[24:27], s46 offen
    s_waitcnt vmcnt(13)
    v_mfma_f32_32x32x16_bf16 a[64:79], v[68:71], a[40:43], a[64:79]
    v_mfma_f32_32x32x16_bf16 a[80:95], v[72:75], a[40:43], a[80:95]
    v_mfma_f32_32x32x16_bf16 a[96:111], v[68:71], a[44:47], a[96:111]
    v_mfma_f32_32x32x16_bf16 a[112:127], v[72:75], a[44:47], a[112:127]
    v_add_u32 v134, 2, v133
    v_mul_u32_u24 v135, s56, v134
    v_lshrrev_b32 v135, 16, v135
    v_mul_u32_u24 v136, 14, v135
    v_sub_u32 v136, v134, v136
    v_lshrrev_b32 v137, 1, v135
    v_mad_u32_u24 v136, v137, 14, v136
    v_and_b32 v135, 1, v135
    v_lshrrev_b32 v137, 3, v136
    v_lshl_add_u32 v137, v137, 10, v132
    v_lshl_add_u32 v137, v135, 9, v137
    v_and_b32 v136, 7, v136
    v_lshl_add_u32 v137, v136, 1, v137
    buffer_load_dword v125, v137, s[24:27], s46 offen
    s_waitcnt vmcnt(12)
    v_mfma_f32_32x32x16_bf16 a[64:79], v[76:79], a[48:51], a[64:79]
    v_mfma_f32_32x32x16_bf16 a[80:95], v[80:83], a[48:51], a[80:95]
    v_mfma_f32_32x32x16_bf16 a[96:111], v[76:79], a[52:55], a[96:111]
    v_mfma_f32_32x32x16_bf16 a[112:127], v[80:83], a[52:55], a[112:127]
    v_add_u32 v134, 4, v133
    v_mul_u32_u24 v135, s56, v134
    v_lshrrev_b32 v135, 16, v135
    v_mul_u32_u24 v136, 14, v135
    v_sub_u32 v136, v134, v136
    v_lshrrev_b32 v137, 1, v135
    v_mad_u32_u24 v136, v137, 14, v136
    v_and_b32 v135, 1, v135
    v_lshrrev_b32 v137, 3, v136
    v_lshl_add_u32 v137, v137, 10, v132
    v_lshl_add_u32 v137, v135, 9, v137
    v_and_b32 v136, 7, v136
    v_lshl_add_u32 v137, v136, 1, v137
    buffer_load_dword v126, v137, s[24:27], s46 offen
    s_waitcnt vmcnt(11)
    v_mfma_f32_32x32x16_bf16 a[64:79], v[84:87], a[56:59], a[64:79]
    v_mfma_f32_32x32x16_bf16 a[80:95], v[88:91], a[56:59], a[80:95]
    v_mfma_f32_32x32x16_bf16 a[96:111], v[84:87], a[60:63], a[96:111]
    v_mfma_f32_32x32x16_bf16 a[112:127], v[88:91], a[60:63], a[112:127]
    v_add_u32 v134, 6, v133
    v_mul_u32_u24 v135, s56, v134
    v_lshrrev_b32 v135, 16, v135
    v_mul_u32_u24 v136, 14, v135
    v_sub_u32 v136, v134, v136
    v_lshrrev_b32 v137, 1, v135
    v_mad_u32_u24 v136, v137, 14, v136
    v_and_b32 v135, 1, v135
    v_lshrrev_b32 v137, 3, v136
    v_lshl_add_u32 v137, v137, 10, v132
    v_lshl_add_u32 v137, v135, 9, v137
    v_and_b32 v136, 7, v136
    v_lshl_add_u32 v137, v136, 1, v137
    buffer_load_dword v127, v137, s[24:27], s46 offen
    s_waitcnt vmcnt(10)
    v_mfma_f32_32x32x16_bf16 a[64:79], v[92:95], a[0:3], a[64:79]
    v_mfma_f32_32x32x16_bf16 a[80:95], v[96:99], a[0:3], a[80:95]
    v_mfma_f32_32x32x16_bf16 a[96:111], v[92:95], a[4:7], a[96:111]
    v_mfma_f32_32x32x16_bf16 a[112:127], v[96:99], a[4:7], a[112:127]
    v_add_u32 v134, 8, v133
    v_mul_u32_u24 v135, s56, v134
    v_lshrrev_b32 v135, 16, v135
    v_mul_u32_u24 v136, 14, v135
    v_sub_u32 v136, v134, v136
    v_lshrrev_b32 v137, 1, v135
    v_mad_u32_u24 v136, v137, 14, v136
    v_and_b32 v135, 1, v135
    v_lshrrev_b32 v137, 3, v136
    v_lshl_add_u32 v137, v137, 10, v132
    v_lshl_add_u32 v137, v135, 9, v137
    v_and_b32 v136, 7, v136
    v_lshl_add_u32 v137, v136, 1, v137
    buffer_load_dword v128, v137, s[24:27], s46 offen
    s_waitcnt vmcnt(9)
    v_mfma_f32_32x32x16_bf16 a[64:79], v[100:103], a[8:11], a[64:79]
    v_mfma_f32_32x32x16_bf16 a[80:95], v[104:107], a[8:11], a[80:95]
    v_mfma_f32_32x32x16_bf16 a[96:111], v[100:103], a[12:15], a[96:111]
    v_mfma_f32_32x32x16_bf16 a[112:127], v[104:107], a[12:15], a[112:127]
    v_add_u32 v134, 10, v133
    v_mul_u32_u24 v135, s56, v134
    v_lshrrev_b32 v135, 16, v135
    v_mul_u32_u24 v136, 14, v135
    v_sub_u32 v136, v134, v136
    v_lshrrev_b32 v137, 1, v135
    v_mad_u32_u24 v136, v137, 14, v136
    v_and_b32 v135, 1, v135
    v_lshrrev_b32 v137, 3, v136
    v_lshl_add_u32 v137, v137, 10, v132
    v_lshl_add_u32 v137, v135, 9, v137
    v_and_b32 v136, 7, v136
    v_lshl_add_u32 v137, v136, 1, v137
    buffer_load_dword v129, v137, s[24:27], s46 offen
    s_waitcnt vmcnt(8)
    v_mfma_f32_32x32x16_bf16 a[64:79], v[108:111], a[16:19], a[64:79]
    v_mfma_f32_32x32x16_bf16 a[80:95], v[112:115], a[16:19], a[80:95]
    v_mfma_f32_32x32x16_bf16 a[96:111], v[108:111], a[20:23], a[96:111]
    v_mfma_f32_32x32x16_bf16 a[112:127], v[112:115], a[20:23], a[112:127]
    v_add_u32 v134, 12, v133
    v_mul_u32_u24 v135, s56, v134
    v_lshrrev_b32 v135, 16, v135
    v_mul_u32_u24 v136, 14, v135
    v_sub_u32 v136, v134, v136
    v_lshrrev_b32 v137, 1, v135
    v_mad_u32_u24 v136, v137, 14, v136
    v_and_b32 v135, 1, v135
    v_lshrrev_b32 v137, 3, v136
    v_lshl_add_u32 v137, v137, 10, v132
    v_lshl_add_u32 v137, v135, 9, v137
    v_and_b32 v136, 7, v136
    v_lshl_add_u32 v137, v136, 1, v137
    buffer_load_dword v130, v137, s[24:27], s46 offen
    s_waitcnt vmcnt(7)
    v_mfma_f32_32x32x16_bf16 a[64:79], v[116:119], a[24:27], a[64:79]
    v_mfma_f32_32x32x16_bf16 a[80:95], v[120:123], a[24:27], a[80:95]
    v_mfma_f32_32x32x16_bf16 a[96:111], v[116:119], a[28:31], a[96:111]
    v_mfma_f32_32x32x16_bf16 a[112:127], v[120:123], a[28:31], a[112:127]
    v_add_u32 v134, 14, v133
    v_mul_u32_u24 v135, s56, v134
    v_lshrrev_b32 v135, 16, v135
    v_mul_u32_u24 v136, 14, v135
    v_sub_u32 v136, v134, v136
    v_lshrrev_b32 v137, 1, v135
    v_mad_u32_u24 v136, v137, 14, v136
    v_and_b32 v135, 1, v135
    v_lshrrev_b32 v137, 3, v136
    v_lshl_add_u32 v137, v137, 10, v132
    v_lshl_add_u32 v137, v135, 9, v137
    v_and_b32 v136, 7, v136
    v_lshl_add_u32 v137, v136, 1, v137
    buffer_load_dword v131, v137, s[24:27], s46 offen
    s_lshl_b32 s32, s3, 14
    v_add_u32 v5, s32, v2
    s_cmp_eq_u32 s3, 0
    s_cbranch_scc1 KB_own0
    ds_write_b128 v5, a[64:67] offset:0
    ds_write_b128 v5, a[68:71] offset:1024
    ds_write_b128 v5, a[72:75] offset:2048
    ds_write_b128 v5, a[76:79] offset:3072
    s_branch KB_nxt0
KB_own0:
    v_accvgpr_read_b32 v16, a64
    v_accvgpr_read_b32 v17, a65
    v_accvgpr_read_b32 v18, a66
    v_accvgpr_read_b32 v19, a67
    v_accvgpr_read_b32 v20, a68
    v_accvgpr_read_b32 v21, a69
    v_accvgpr_read_b32 v22, a70
    v_accvgpr_read_b32 v23, a71
    v_accvgpr_read_b32 v24, a72
    v_accvgpr_read_b32 v25, a73
    v_accvgpr_read_b32 v26, a74
    v_accvgpr_read_b32 v27, a75
    v_accvgpr_read_b32 v28, a76
    v_accvgpr_read_b32 v29, a77
    v_accvgpr_read_b32 v30, a78
    v_accvgpr_read_b32 v31, a79
KB_nxt0:
    s_cmp_eq_u32 s3, 1
    s_cbranch_scc1 KB_own1
    ds_write_b128 v5, a[80:83] offset:4096
    ds_write_b128 v5, a[84:87] offset:5120
    ds_write_b128 v5, a[88:91] offset:6144
    ds_write_b128 v5, a[92:95] offset:7168
    s_branch KB_nxt1
KB_own1:
    v_accvgpr_read_b32 v16, a80
    v_accvgpr_read_b32 v17, a81
    v_accvgpr_read_b32 v18, a82
    v_accvgpr_read_b32 v19, a83
    v_accvgpr_read_b32 v20, a84
    v_accvgpr_read_b32 v21, a85
    v_accvgpr_read_b32 v22, a86
    v_accvgpr_read_b32 v23, a87
    v_accvgpr_read_b32 v24, a88
    v_accvgpr_read_b32 v25, a89
    v_accvgpr_read_b32 v26, a90
    v_accvgpr_read_b32 v27, a91
    v_accvgpr_read_b32 v28, a92
    v_accvgpr_read_b32 v29, a93
    v_accvgpr_read_b32 v30, a94
    v_accvgpr_read_b32 v31, a95
KB_nxt1:
    s_cmp_eq_u32 s3, 2
    s_cbranch_scc1 KB_own2
    ds_write_b128 v5, a[96:99] offset:8192
    ds_write_b128 v5, a[100:103] offset:9216
    ds_write_b128 v5, a[104:107] offset:10240
    ds_write_b128 v5, a[108:111] offset:11264
    s_branch KB_nxt2
KB_own2:
    v_accvgpr_read_b32 v16, a96
    v_accvgpr_read_b32 v17, a97
    v_accvgpr_read_b32 v18, a98
    v_accvgpr_read_b32 v19, a99
    v_accvgpr_read_b32 v20, a100
    v_accvgpr_read_b32 v21, a101
    v_accvgpr_read_b32 v22, a102
    v_accvgpr_read_b32 v23, a103
    v_accvgpr_read_b32 v24, a104
    v_accvgpr_read_b32 v25, a105
    v_accvgpr_read_b32 v26, a106
    v_accvgpr_read_b32 v27, a107
    v_accvgpr_read_b32 v28, a108
    v_accvgpr_read_b32 v29, a109
    v_accvgpr_read_b32 v30, a110
    v_accvgpr_read_b32 v31, a111
KB_nxt2:
    s_cmp_eq_u32 s3, 3
    s_cbranch_scc1 KB_own3
    ds_write_b128 v5, a[112:115] offset:12288
    ds_write_b128 v5, a[116:119] offset:13312
    ds_write_b128 v5, a[120:123] offset:14336
    ds_write_b128 v5, a[124:127] offset:15360
    s_branch KB_nxt3
KB_own3:
    v_accvgpr_read_b32 v16, a112
    v_accvgpr_read_b32 v17, a113
    v_accvgpr_read_b32 v18, a114
    v_accvgpr_read_b32 v19, a115
    v_accvgpr_read_b32 v20, a116
    v_accvgpr_read_b32 v21, a117
    v_accvgpr_read_b32 v22, a118
    v_accvgpr_read_b32 v23, a119
    v_accvgpr_read_b32 v24, a120
    v_accvgpr_read_b32 v25, a121
    v_accvgpr_read_b32 v26, a122
    v_accvgpr_read_b32 v27, a123
    v_accvgpr_read_b32 v28, a124
    v_accvgpr_read_b32 v29, a125
    v_accvgpr_read_b32 v30, a126
    v_accvgpr_read_b32 v31, a127
KB_nxt3:
    s_lshl_b32 s32, s3, 12
    s_add_u32 s33, s3, 1
    s_and_b32 s33, s33, 3
    s_lshl_b32 s33, s33, 14
    s_add_u32 s33, s33, s32
    v_add_u32 v5, s33, v2
    s_add_u32 s33, s3, 2
    s_and_b32 s33, s33, 3
    s_lshl_b32 s33, s33, 14
    s_add_u32 s33, s33, s32
    v_add_u32 v6, s33, v2
    s_add_u32 s33, s3, 3
    s_and_b32 s33, s33, 3
    s_lshl_b32 s33, s33, 14
    s_add_u32 s33, s33, s32
    v_add_u32 v7, s33, v2
    s_waitcnt lgkmcnt(0)
    s_barrier
    ds_read_b128 v[32:35], v5 offset:0
    ds_read_b128 v[36:39], v5 offset:1024
    ds_read_b128 v[40:43], v5 offset:2048
    ds_read_b128 v[44:47], v5 offset:3072
    ds_read_b128 v[48:51], v6 offset:0
    ds_read_b128 v[52:55], v6 offset:1024
    ds_read_b128 v[56:59], v6 offset:2048
    ds_read_b128 v[60:63], v6 offset:3072
    ds_read_b128 v[64:67], v7 offset:0
    ds_read_b128 v[68:71], v7 offset:1024
    ds_read_b128 v[72:75], v7 offset:2048
    ds_read_b128 v[76:79], v7 offset:3072
    s_waitcnt lgkmcnt(8)
    v_add_f32 v16, v16, v32
    v_add_f32 v17, v17, v33
    v_add_f32 v18, v18, v34
    v_add_f32 v19, v19, v35
    v_add_f32 v20, v20, v36
    v_add_f32 v21, v21, v37
    v_add_f32 v22, v22, v38
    v_add_f32 v23, v23, v39
    v_add_f32 v24, v24, v40
    v_add_f32 v25, v25, v41
    v_add_f32 v26, v26, v42
    v_add_f32 v27, v27, v43
    v_add_f32 v28, v28, v44
    v_add_f32 v29, v29, v45
    v_add_f32 v30, v30, v46
    v_add_f32 v31, v31, v47
    s_waitcnt lgkmcnt(0)
    v_add_f32 v48, v48, v64
    v_add_f32 v49, v49, v65
    v_add_f32 v50, v50, v66
    v_add_f32 v51, v51, v67
    v_add_f32 v52, v52, v68
    v_add_f32 v53, v53, v69
    v_add_f32 v54, v54, v70
    v_add_f32 v55, v55, v71
    v_add_f32 v56, v56, v72
    v_add_f32 v57, v57, v73
    v_add_f32 v58, v58, v74
    v_add_f32 v59, v59, v75
    v_add_f32 v60, v60, v76
    v_add_f32 v61, v61, v77
    v_add_f32 v62, v62, v78
    v_add_f32 v63, v63, v79
    v_add_f32 v16, v16, v48
    v_add_f32 v17, v17, v49
    v_add_f32 v18, v18, v50
    v_add_f32 v19, v19, v51
    v_add_f32 v20, v20, v52
    v_add_f32 v21, v21, v53
    v_add_f32 v22, v22, v54
    v_add_f32 v23, v23, v55
    v_add_f32 v24, v24, v56
    v_add_f32 v25, v25, v57
    v_add_f32 v26, v26, v58
    v_add_f32 v27, v27, v59
    v_add_f32 v28, v28, v60
    v_add_f32 v29, v29, v61
    v_add_f32 v30, v30, v62
    v_add_f32 v31, v31, v63
    s_waitcnt vmcnt(0)
    v_lshlrev_b32 v6, 16, v124
    v_and_b32 v7, 0xffff0000, v124
    v_add_f32 v6, v6, v16
    v_add_f32 v7, v7, v17
    v_cvt_pk_bf16_f32 v80, v6, v7
    v_lshlrev_b32 v6, 16, v125
    v_and_b32 v7, 0xffff0000, v125
    v_add_f32 v6, v6, v18
    v_add_f32 v7, v7, v19
    v_cvt_pk_bf16_f32 v81, v6, v7
    v_lshlrev_b32 v6, 16, v126
    v_and_b32 v7, 0xffff0000, v126
    v_add_f32 v6, v6, v20
    v_add_f32 v7, v7, v21
    v_cvt_pk_bf16_f32 v82, v6, v7
    v_lshlrev_b32 v6, 16, v127
    v_and_b32 v7, 0xffff0000, v127
    v_add_f32 v6, v6, v22
    v_add_f32 v7, v7, v23
    v_cvt_pk_bf16_f32 v83, v6, v7
    v_lshlrev_b32 v6, 16, v128
    v_and_b32 v7, 0xffff0000, v128
    v_add_f32 v6, v6, v24
    v_add_f32 v7, v7, v25
    v_cvt_pk_bf16_f32 v84, v6, v7
    v_lshlrev_b32 v6, 16, v129
    v_and_b32 v7, 0xffff0000, v129
    v_add_f32 v6, v6, v26
    v_add_f32 v7, v7, v27
    v_cvt_pk_bf16_f32 v85, v6, v7
    v_lshlrev_b32 v6, 16, v130
    v_and_b32 v7, 0xffff0000, v130
    v_add_f32 v6, v6, v28
    v_add_f32 v7, v7, v29
    v_cvt_pk_bf16_f32 v86, v6, v7
    v_lshlrev_b32 v6, 16, v131
    v_and_b32 v7, 0xffff0000, v131
    v_add_f32 v6, v6, v30
    v_add_f32 v7, v7, v31
    v_cvt_pk_bf16_f32 v87, v6, v7
    buffer_store_dwordx4 v[80:83], v3, s[20:23], 0 offen
    buffer_store_dwordx4 v[84:87], v3, s[20:23], 0 offen offset:16
KB_fin:
KB_done:
    s_endpgm
.section .rodata,"a"
.p2align 6
.amdhsa_kernel k1_kernel
  .amdhsa_next_free_vgpr 256
  .amdhsa_next_free_sgpr 102
  .amdhsa_accum_offset 256
  .amdhsa_group_segment_fixed_size 0
  .amdhsa_kernarg_size 88
  .amdhsa_user_sgpr_count 2
  .amdhsa_user_sgpr_kernarg_segment_ptr 1
  .amdhsa_system_sgpr_workgroup_id_x 1
.end_amdhsa_kernel
.p2align 6
.amdhsa_kernel kb_kernel
  .amdhsa_next_free_vgpr 512
  .amdhsa_next_free_sgpr 102
  .amdhsa_accum_offset 256
  .amdhsa_group_segment_fixed_size 0
  .amdhsa_kernarg_size 88
  .amdhsa_user_sgpr_count 2
  .amdhsa_user_sgpr_kernarg_segment_ptr 1
  .amdhsa_system_sgpr_workgroup_id_x 1
.end_amdhsa_kernel
```
